```python
import torch

def _softmax(x, axis=-1):
    return torch.softmax(x, dim=axis)
def _gelu(x):
    return torch.nn.functional.gelu(x, approximate="tanh")
def _silu(x):
    return torch.nn.functional.silu(x)
def _sigmoid(x):
    return torch.sigmoid(x)
def _layernorm(x, axis=-1, eps=1e-5):
    m = x.mean(dim=axis, keepdim=True)
    v = x.var(dim=axis, keepdim=True, unbiased=False)
    return (x - m) / torch.sqrt(v + eps)
def _scatter_add(tgt, idx, src, axis=0):
    return tgt.clone().index_add_(axis, idx, src)
def _segment_sum(src, seg, n):
    out = torch.zeros((n,) + src.shape[1:], dtype=src.dtype)
    return out.index_add_(0, seg, src)
def _pad(x, pw):
    flat = tuple(v for pair in reversed(pw) for v in pair)
    return torch.nn.functional.pad(x, flat)

kernel_name = 'gated_mix__ssm_conv_s4__ssm_conv_s4d__prompt'

def setup_inputs():

    _w = (lambda a: (lambda t: t.to(torch.bfloat16) if t.is_floating_point() else t)(torch.as_tensor(a)))
    def _A_setup():
        B, L, D, N = 1, 2048, 640, 192
        A_re = -(lambda _x: torch.exp(torch.as_tensor(_x)))((lambda *s: torch.randn(*s, dtype=torch.bfloat16) * 6.4)(D, N))
        A_im = torch.pi * (lambda *s: torch.randn(*s, dtype=torch.bfloat16) * 0.05)(D, N)
        B_re = (lambda *s: torch.randn(*s, dtype=torch.bfloat16) * 0.05)(D, N)
        B_im = (lambda *s: torch.randn(*s, dtype=torch.bfloat16) * 0.05)(D, N)
        C_re = (lambda *s: torch.randn(*s, dtype=torch.bfloat16) * 0.05)(D, N)
        C_im = (lambda *s: torch.randn(*s, dtype=torch.bfloat16) * 0.05)(D, N)
        log_dt = (lambda *s: torch.randn(*s, dtype=torch.bfloat16) * 0.05)(D) * 0.5 - 4.0
        Dskip = (lambda *s: torch.randn(*s, dtype=torch.bfloat16) * 0.05)(D)
        return {
            "u": _w((lambda *s: torch.randn(*s, dtype=torch.bfloat16) * 0.05)(B, L, D)),
            "A_re": _w(A_re),
            "A_im": _w(A_im),
            "B_re": _w(B_re),
            "B_im": _w(B_im),
            "C_re": _w(C_re),
            "C_im": _w(C_im),
            "log_dt": _w(log_dt),
            "Dskip": _w(Dskip),
        }
    _A_in = _A_setup()

    def _B_setup():
        Bsz, L, D, N = 1, 2048, 640, 192
        return {
            "u": _w((lambda *s: torch.randn(*s, dtype=torch.bfloat16) * 0.05)(Bsz, L, D)),
            "log_A_real": _w((lambda *s: torch.randn(*s, dtype=torch.bfloat16) * 6.4)(D, N) * 0.5),
            "A_imag": _w((lambda *s: torch.randn(*s, dtype=torch.bfloat16) * 0.05)(D, N) * 3.14),
            "C_real": _w((lambda *s: torch.randn(*s, dtype=torch.bfloat16) * 0.05)(D, N) / N ** 0.5),
            "C_imag": _w((lambda *s: torch.randn(*s, dtype=torch.bfloat16) * 0.05)(D, N) / N ** 0.5),
            "log_dt": _w((lambda *s: torch.randn(*s, dtype=torch.bfloat16) * 0.05)(D) * 0.5 - 4.0),
            "D_skip": _w((lambda *s: torch.randn(*s, dtype=torch.bfloat16) * 0.05)(D)),
        }
    _B_in = _B_setup()

    return {
        "A_u": _A_in["u"],
        "A_A_re": _A_in["A_re"],
        "A_A_im": _A_in["A_im"],
        "A_B_re": _A_in["B_re"],
        "A_B_im": _A_in["B_im"],
        "A_C_re": _A_in["C_re"],
        "A_C_im": _A_in["C_im"],
        "A_log_dt": _A_in["log_dt"],
        "A_Dskip": _A_in["Dskip"],
        "B_u": _B_in["u"],
        "B_log_A_real": _B_in["log_A_real"],
        "B_A_imag": _B_in["A_imag"],
        "B_C_real": _B_in["C_real"],
        "B_C_imag": _B_in["C_imag"],
        "B_log_dt": _B_in["log_dt"],
        "B_D_skip": _B_in["D_skip"],
        "gate_w": _w((lambda *s: torch.randn(*s, dtype=torch.bfloat16) * 0.05)(640) * 16.0),
    }

def reference(A_u, A_A_re, A_A_im, A_B_re, A_B_im, A_C_re, A_C_im, A_log_dt, A_Dskip, B_u, B_log_A_real, B_A_imag, B_C_real, B_C_imag, B_log_dt, B_D_skip, gate_w):
    def _A_ref(u, A_re, A_im, B_re, B_im, C_re, C_im, log_dt, Dskip):
        Bsz, L, D = u.shape
        dt = torch.exp(log_dt)[:, None]
        A = A_re + 1j * A_im
        Bc = B_re + 1j * B_im
        Cc = C_re + 1j * C_im
        logdA = dt * A
        dB = dt * Bc
        l = (lambda x, dt: x.to(dt))(torch.arange(L), A_re.dtype)
        P = torch.exp(logdA[:, :, None] * l[None, None, :])
        K = torch.einsum("dn,dnl,dn->dl", Cc, P, dB).real
        L2 = 2 * L
        Kp = _pad(K, ((0, 0), (0, L)))
        up = (lambda x, *d: x.permute(*d))(u, 0, 2, 1)
        up = _pad(up, ((0, 0), (0, 0), (0, L)))
        Kf = (lambda x, axes=(-2,-1): torch.fft.rfft2(x.float(), dim=axes))(Kp[:, None, :], axes=(-2, -1))
        Uf = (lambda x, axes=(-2,-1): torch.fft.rfft2(x.float(), dim=axes))(up[:, :, None, :], axes=(-2, -1))
        Yf = Uf * Kf[None, :, :, :]
        y = (lambda x, s, axes=(-2,-1): torch.fft.irfft2(x, s=s, dim=axes).to(torch.bfloat16))(Yf, (1, L2), axes=(-2, -1))[:, :, 0, :L]
        y = (lambda x, *d: x.permute(*d))(y, 0, 2, 1) + u * Dskip[None, None, :]
        return y

    def _B_ref(u, log_A_real, A_imag, C_real, C_imag, log_dt, D_skip):
        L = u.shape[1]
        dt = torch.exp(log_dt)
        A = -torch.exp(log_A_real) + 1j * A_imag
        C = (C_real + 1j * C_imag) * dt[:, None]
        pos = (lambda x, dt: x.to(dt))(torch.arange(L), log_dt.dtype)
        P = torch.exp((A * dt[:, None])[:, :, None] * pos[None, None, :])
        K = 2.0 * torch.einsum("dn,dnl->dl", C, P).real
        L2 = 2 * L
        u_t = (lambda x, *d: x.permute(*d))(u, 0, 2, 1)
        Kf = (lambda x, *a, **k: torch.fft.rfft(x.float(), *a, **k))(K, L2)
        Uf = (lambda x, *a, **k: torch.fft.rfft(x.float(), *a, **k))(u_t, L2)
        y = (lambda x, *a, **k: torch.fft.irfft(x, *a, **k).to(torch.bfloat16))(Uf * Kf[None, :, :], L2)[:, :, :L]
        y = (lambda x, *d: x.permute(*d))(y, 0, 2, 1)
        return y + u * D_skip[None, None, :]

    x = A_u
    g = _sigmoid((x * gate_w).sum(-1, keepdims=True))
    a = _A_ref(x, A_A_re, A_A_im, A_B_re, A_B_im, A_C_re, A_C_im, A_log_dt, A_Dskip)
    b = _B_ref(x, B_log_A_real, B_A_imag, B_C_real, B_C_imag, B_log_dt, B_D_skip)
    return g * a + (1 - g) * b
```

```asm
; @launch grid=(256,1,1) block=(512,1,1) lds=160000
.amdgcn_target "amdgcn-amd-amdhsa--gfx950"
.text
.globl gated_mix__ssm_conv_s4__ssm_conv_s4d__prompt_kernel
.p2align 12
.p2align 8
.type gated_mix__ssm_conv_s4__ssm_conv_s4d__prompt_kernel,@function
gated_mix__ssm_conv_s4__ssm_conv_s4d__prompt_kernel:
    s_load_dwordx16 s[4:19], s[0:1], 0
    s_load_dwordx16 s[20:35], s[0:1], 64
    s_load_dwordx8 s[36:43], s[0:1], 128
    s_lshr_b32 s45, s2, 3
    s_cmp_ge_u32 s45, 32
    s_cbranch_scc1 L_end
    s_getpc_b64 s[70:71]
L_pc:
    v_lshl_add_u32 v1, s45, 9, v0
    v_mul_u32_u24 v1, 45, v1
    v_lshrrev_b32 v1, 5, v1
    global_load_ubyte v50, v1, s[70:71]
    v_lshrrev_b32 v1, 6, v0
    v_and_b32 v0, 63, v0
    v_readfirstlane_b32 s3, v1
    s_and_b32 s44, s2, 7
    s_sub_u32 s46, s45, 4
    s_cbranch_scc1 L_light
    v_lshlrev_b32 v47, 4, v0
    v_add_u32 v3, L_tab-L_pc, v47
    global_load_dwordx4 v[120:123], v3, s[70:71]
    s_movk_i32 m0, 13056
    v_mov_b32 v5, 0
    ds_write_addtid_b32 v5 offset:65280
    s_mul_i32 s49, s46, 3
    s_lshr_b32 s48, s49, 5
    s_andn2_b32 s50, s49, 31
    s_sub_u32 s49, s49, s48
    s_add_u32 s50, s50, 29
    s_min_u32 s49, s49, s50
    s_movk_i32 s50, 77
    s_min_u32 s49, s49, s50
    s_sub_u32 s48, s50, s49
    s_bitcmp1_b32 s44, 0
    s_cselect_b32 s49, s48, s49
    s_mul_i32 s47, s44, 5
    s_lshl4_add_u32 s47, s47, s49
    s_lshl_b32 s48, s3, 2
    s_lshr_b32 s58, 0x68302630, s48
    s_lshr_b32 s51, 0x67304630, s48
    v_mov_b32 v1, s58
    s_mov_b32 exec_lo, 0
    v_mov_b32 v1, s51
    s_mov_b32 exec_lo, -1
    s_mul_i32 s49, s47, 3
    v_and_b32 v1, 15, v1
    v_add_lshl_u32 v2, v1, s49, 7
    v_lshl_add_u32 v1, v0, 2, v2
    s_lshr_b32 s52, s3, 2
    s_sub_u32 exec_hi, s52, 1
    s_cmp_eq_u32 s3, 6
    s_cselect_b32 exec_lo, -1, exec_hi
    s_waitcnt lgkmcnt(0)
    s_cbranch_execz L_ldB
    global_load_dword v18, v1, s[14:15]
    global_load_dword v19, v1, s[16:17]
    global_load_dword v24, v1, s[10:11]
    global_load_dword v25, v1, s[12:13]
    global_load_dword v12, v1, s[6:7]
    global_load_dword v13, v1, s[8:9]
L_ldB:
    s_not_b64 exec, exec
    s_cbranch_execz L_ld1
    global_load_dword v18, v1, s[28:29]
    global_load_dword v19, v1, s[30:31]
    global_load_dword v12, v1, s[24:25]
    global_load_dword v13, v1, s[26:27]
L_ld1:
    s_mov_b64 exec, -1
    s_bitcmp1_b32 0x30, s3
    s_cselect_b32 s68, 1, 0
    s_cbranch_scc0 L_ld2
    v_lshl_add_u32 v2, v0, 1, v2
    global_load_short_d16_hi v20, v2, s[28:29] offset:256
    global_load_short_d16_hi v21, v2, s[30:31] offset:256
    global_load_short_d16_hi v14, v2, s[24:25] offset:256
    global_load_short_d16_hi v15, v2, s[26:27] offset:256
L_ld2:
    s_andn2_b32 s101, s47, 1
    s_lshl_b32 s101, s101, 1
    s_cmp_eq_u32 s52, 1
    s_cselect_b64 s[32:33], s[32:33], s[18:19]
    s_cselect_b64 s[20:21], s[34:35], s[20:21]
    s_load_dwordx2 s[60:61], s[32:33], s101
    s_load_dwordx2 s[66:67], s[18:19], s101
    s_load_dwordx2 s[62:63], s[20:21], s101
    s_load_dword s55, s[42:43], 8448
    s_barrier
    s_cmp_lt_u32 s3, 6
    s_cbranch_scc1 L_init2
    s_and_b32 s49, s3, 1
    s_lshl1_add_u32 s50, s45, s49
    s_mul_i32 s50, s50, 40960
    s_mul_i32 s49, s44, 160
    s_add_u32 s50, s50, s49
    v_lshrrev_b32 v5, 1, v0
    v_mul_u32_u24 v5, 1280, v5
    v_and_b32 v6, 1, v0
    v_mul_u32_u24 v6, 156, v6
    v_add3_u32 v5, v5, v6, s50
    global_load_dword v50, v5, s[4:5]
L_init2:
    s_bitcmp1_b32 0x48, s3
    s_cselect_b32 s54, 1, 0
    s_and_b32 s58, s58, 15
    s_mul_i32 s58, s58, 11
    s_lshr_b32 s58, s58, 5
    global_load_dwordx4 v[244:247], v3, s[70:71] offset:1024
    s_and_b32 s74, s3, 3
    s_cmp_eq_u32 s74, 3
    s_cselect_b32 s48, 0, 2048
    v_add_u32 v3, s48, v3
    s_bitcmp1_b32 0x70, s3
    s_cselect_b64 exec, 1, -1
    global_load_dwordx4 v[248:251], v3, s[70:71] offset:2048
    global_load_dwordx4 v[252:255], v3, s[70:71] offset:3072
    s_mov_b64 exec, -1
    s_mul_i32 s69, s3, 8064
    s_mov_b32 m0, s69
    v_mov_b32 v5, 0x3c00
    v_mov_b32 v34, 0x3fb8aa3b
    v_mov_b32 v35, 0.15915494
    ds_write_addtid_b32 v5 offset:13824
    v_mov_b32 v60, 0
    v_mov_b32 v61, 0
    v_pk_mov_b32 v[62:63], v[60:61], v[60:61]
    v_pk_mov_b32 v[64:65], v[60:61], v[60:61]
    v_pk_mov_b32 v[66:67], v[60:61], v[60:61]
    v_pk_mov_b32 v[68:69], v[60:61], v[60:61]
    v_pk_mov_b32 v[70:71], v[60:61], v[60:61]
    s_cmp_eq_u32 s68, 1
    s_cbranch_scc1 L_nz3
    v_pk_mov_b32 v[20:21], v[60:61], v[60:61]
    v_pk_mov_b32 v[14:15], v[60:61], v[60:61]
L_nz3:
    s_mov_b32 s75, 262144
    s_add_u32 s53, s68, 2
    s_lshl1_add_u32 s73, s58, s52
    s_mul_i32 s73, s73, 7936
    s_add_u32 s73, s73, 91904
    s_cmp_eq_u32 s3, 3
    s_cselect_b32 s74, 0, s74
    s_mul_i32 s48, s74, 3072
    s_add_u32 s48, s48, 147712
    v_add_u32 v48, s48, v47
    s_lshl2_add_u32 s48, s74, 78352
    v_mov_b32 v49, s48
    s_mul_i32 s49, s52, 1310720
    s_add_u32 s49, s49, s101
    v_mul_u32_u24 v46, 2560, v0
    v_add_u32 v46, s49, v46
    s_and_b32 s48, s47, 1
    s_add_u32 s58, s58, s48
    s_cmp_eq_u32 s3, 3
    s_addc_u32 s59, s58, 0
    s_lshl_b32 s58, s58, 4
    s_lshl_b32 s59, s59, 4
    s_cmp_eq_u32 s3, 6
    s_waitcnt lgkmcnt(0)
    s_cselect_b64 s[66:67], s[66:67], s[60:61]
    s_lshr_b64 s[48:49], s[66:67], s58
    s_lshr_b64 s[50:51], s[60:61], s59
    s_lshr_b64 s[62:63], s[62:63], s58
    s_lshl_b32 s48, s48, 16
    s_lshl_b32 s50, s50, 16
    s_lshl_b32 s62, s62, 16
    v_mul_f32 v5, s48, v34
    v_mul_f32 v6, s50, v34
    v_exp_f32 v5, v5
    v_exp_f32 v6, v6
    v_mov_b32 v4, 0xffff0000
    v_cvt_pk_bf16_f32 v5, v5, v6
    v_lshlrev_b32 v31, 16, v5
    v_and_b32 v32, v4, v5
    v_mul_f32 v52, v31, v34
    v_mul_f32 v53, v31, v35
    v_mul_f32 v54, v32, v34
    v_mul_f32 v55, v32, v35
    s_or_b32 s48, s68, s54
    s_setprio 1
    s_cbranch_scc0 L_kp
    s_setprio 2
L_kp:
    s_cmp_eq_u32 s54, 1
    s_cbranch_scc0 L_kgenN
    global_load_dwordx2 v[164:165], v46, s[4:5]
    global_load_dwordx2 v[166:167], v46, s[4:5] offset:1280
    v_add_u32 v46, 163840, v46
    global_load_dwordx2 v[168:169], v46, s[4:5]
    global_load_dwordx2 v[170:171], v46, s[4:5] offset:1280
    v_add_u32 v46, 163840, v46
    global_load_dwordx2 v[172:173], v46, s[4:5]
    global_load_dwordx2 v[174:175], v46, s[4:5] offset:1280
    s_waitcnt vmcnt(10)
    s_cmp_eq_u32 s3, 6
    s_cbranch_scc1 L_k6
    s_waitcnt vmcnt(9)
L_k6:
    v_lshlrev_b32 v16, 16, v18
    v_and_b32 v18, v4, v18
    v_lshlrev_b32 v17, 16, v19
    v_and_b32 v19, v4, v19
    v_lshlrev_b32 v22, 16, v24
    v_and_b32 v24, v4, v24
    v_lshlrev_b32 v23, 16, v25
    v_and_b32 v25, v4, v25
    v_lshlrev_b32 v10, 16, v12
    v_and_b32 v12, v4, v12
    v_lshlrev_b32 v11, 16, v13
    v_and_b32 v13, v4, v13
    v_permlane32_swap_b32 v16, v18
    v_permlane32_swap_b32 v17, v19
    v_permlane32_swap_b32 v22, v24
    v_permlane32_swap_b32 v23, v25
    v_permlane32_swap_b32 v10, v12
    v_permlane32_swap_b32 v11, v13
    s_cbranch_scc0 L_cA
    s_add_u32 s55, s55, 0x9E3779B9
    s_lshl_b32 s51, s2, 7
    s_add_u32 s51, s51, 16384
    v_mov_b32 v5, s51
    v_mov_b32 v6, s55
    s_mov_b64 exec, 1
    global_store_dword v5, v6, s[42:43] sc1
    s_mov_b64 exec, -1
    v_mul_f32 v12, v34, v12
    v_exp_f32 v12, v12
    v_pk_mul_f32 v[36:37], v[16:17], v[22:23] op_sel:[0,0] op_sel_hi:[0,1]
    v_pk_fma_f32 v[16:17], v[16:17], v[22:23], v[36:37] op_sel:[1,1,0] op_sel_hi:[1,0,1] neg_lo:[0,1,0]
    v_mul_f32 v31, 0.5, v31
    v_cvt_pk_bf16_f32 v12, -v12, -v12
    v_and_b32 v12, v4, v12
    s_branch L_cAB
L_kgenN:
    s_waitcnt vmcnt(4)
    s_cmp_eq_u32 s3, 7
    s_cbranch_scc1 L_kgen2
    s_waitcnt vmcnt(3)
L_kgen2:
    v_lshlrev_b32 v16, 16, v18
    v_and_b32 v18, v4, v18
    v_lshlrev_b32 v17, 16, v19
    v_and_b32 v19, v4, v19
    v_lshlrev_b32 v10, 16, v12
    v_and_b32 v12, v4, v12
    v_lshlrev_b32 v11, 16, v13
    v_and_b32 v13, v4, v13
    s_cmp_eq_u32 s52, 1
    s_cbranch_scc1 L_cB
    v_lshlrev_b32 v22, 16, v24
    v_and_b32 v24, v4, v24
    v_lshlrev_b32 v23, 16, v25
    v_and_b32 v25, v4, v25
L_cA:
    v_pk_mul_f32 v[36:37], v[16:17], v[22:23] op_sel:[0,0] op_sel_hi:[0,1]
    v_pk_fma_f32 v[16:17], v[16:17], v[22:23], v[36:37] op_sel:[1,1,0] op_sel_hi:[1,0,1] neg_lo:[0,1,0]
    v_pk_mul_f32 v[36:37], v[18:19], v[24:25] op_sel:[0,0] op_sel_hi:[0,1]
    v_pk_fma_f32 v[18:19], v[18:19], v[24:25], v[36:37] op_sel:[1,1,0] op_sel_hi:[1,0,1] neg_lo:[0,1,0]
    s_branch L_cAB
L_cB:
    v_mul_f32 v10, v34, v10
    v_mul_f32 v12, v34, v12
    v_mul_f32 v14, v34, v14
    v_exp_f32 v10, v10
    v_exp_f32 v12, v12
    v_exp_f32 v14, v14
    v_cvt_pk_bf16_f32 v12, -v10, -v12
    v_cvt_pk_bf16_f32 v14, -v14, -v14
    v_lshlrev_b32 v10, 16, v12
    v_and_b32 v12, v4, v12
    v_lshlrev_b32 v14, 16, v14
L_cAB:
    v_max3_f32 v5, |v16|, |v17|, |v18|
    v_max3_f32 v6, |v19|, |v20|, |v21|
    v_max_f32 v5, v5, v6
    v_pk_mul_f32 v[10:11], v[10:11], v[52:53]
    v_add_u32_sdwa v42, v120, s69 dst_sel:DWORD dst_unused:UNUSED_PAD src0_sel:WORD_0 src1_sel:DWORD
    v_max_f32_dpp v5, v5, v5 row_shr:1 row_mask:0xf bank_mask:0xf bound_ctrl:0
    v_pk_mul_f32 v[12:13], v[12:13], v[54:55]
    v_add_u32_sdwa v40, v120, s69 dst_sel:DWORD dst_unused:UNUSED_PAD src0_sel:WORD_1 src1_sel:DWORD
    v_max_f32_dpp v5, v5, v5 row_shr:2 row_mask:0xf bank_mask:0xf bound_ctrl:0
    v_pk_mul_f32 v[14:15], v[14:15], v[52:53]
    v_add_u32_sdwa v41, v121, s69 dst_sel:DWORD dst_unused:UNUSED_PAD src0_sel:WORD_0 src1_sel:DWORD
    v_max_f32_dpp v5, v5, v5 row_shr:4 row_mask:0xf bank_mask:0xf bound_ctrl:0
    v_exp_f32 v38, v10
    v_add_u32_sdwa v43, v122, s73 dst_sel:DWORD dst_unused:UNUSED_PAD src0_sel:WORD_1 src1_sel:DWORD
    v_max_f32_dpp v5, v5, v5 row_shr:8 row_mask:0xf bank_mask:0xf bound_ctrl:0
    v_cos_f32 v36, v11
    v_add_u32_sdwa v44, v123, s73 dst_sel:DWORD dst_unused:UNUSED_PAD src0_sel:WORD_0 src1_sel:DWORD
    v_max_f32_dpp v5, v5, v5 row_bcast:15 row_mask:0xa bank_mask:0xf
    v_sin_f32 v37, v11
    v_add_u32_sdwa v45, v123, s73 dst_sel:DWORD dst_unused:UNUSED_PAD src0_sel:WORD_1 src1_sel:DWORD
    v_max_f32_dpp v5, v5, v5 row_bcast:31 row_mask:0xc bank_mask:0xf
    v_pk_mul_f32 v[36:37], v[36:37], v[38:39] op_sel:[0,0] op_sel_hi:[1,0]
    v_readlane_b32 s56, v5, 63
    s_cmp_eq_u32 s54, 1
    s_cbranch_scc1 L_nozf
    v_add_u32_sdwa v2, v121, s73 dst_sel:DWORD dst_unused:UNUSED_PAD src0_sel:WORD_1 src1_sel:DWORD
    v_add_u32_sdwa v3, v122, s73 dst_sel:DWORD dst_unused:UNUSED_PAD src0_sel:WORD_0 src1_sel:DWORD
    ds_write_b128 v2, v[60:63]
    ds_write_b128 v2, v[60:63] offset:3968
    ds_write_b128 v3, v[60:63]
L_nozf:
    s_lshr_b32 s56, s56, 23
    s_max_u32 s56, s56, 14
    s_sub_u32 s48, 267, s56
    s_lshl_b32 s48, s48, 23
    s_add_u32 s56, s56, s52
    s_sub_u32 s56, s56, 13
    s_lshl_b32 s56, s56, 23
    v_pk_mul_f32 v[16:17], v[16:17], s[48:49] op_sel_hi:[1,0]
    v_cvt_pk_f16_f32 v28, v16, -v17
    v_pk_mul_f32 v[18:19], v[18:19], s[48:49] op_sel_hi:[1,0]
    v_cvt_pk_f16_f32 v29, v18, -v19
    v_pk_mul_f32 v[20:21], v[20:21], s[48:49] op_sel_hi:[1,0]
    v_cvt_pk_f16_f32 v30, v20, -v21
    v_mul_f32 v31, s56, v31
    v_mul_f32 v32, s56, v32
.p2align 3
L_pass:
    v_cvt_pk_f16_f32 v56, v36, v37
    v_pk_mul_f32 v[38:39], v[36:37], v[36:37] op_sel:[0,0] op_sel_hi:[0,1]
    v_pk_fma_f32 v[36:37], v[36:37], v[36:37], v[38:39] op_sel:[1,1,0] op_sel_hi:[1,0,1] neg_lo:[0,1,0]
    v_cvt_pk_f16_f32 v57, v36, v37
    v_pk_mul_f16 v58, v56, v57 op_sel:[0,0] op_sel_hi:[0,1]
    v_pk_fma_f16 v58, v56, v57, v58 op_sel:[1,1,0] op_sel_hi:[1,0,1] neg_lo:[0,1,0]
    v_pk_mul_f32 v[38:39], v[36:37], v[36:37] op_sel:[0,0] op_sel_hi:[0,1]
    v_pk_fma_f32 v[36:37], v[36:37], v[36:37], v[38:39] op_sel:[1,1,0] op_sel_hi:[1,0,1] neg_lo:[0,1,0]
    v_cvt_pk_f16_f32 v59, v36, v37
    v_pk_mul_f16 v16, v56, v59 op_sel:[0,0] op_sel_hi:[0,1]
    v_pk_fma_f16 v16, v56, v59, v16 op_sel:[1,1,0] op_sel_hi:[1,0,1] neg_lo:[0,1,0]
    v_pk_mul_f16 v17, v57, v59 op_sel:[0,0] op_sel_hi:[0,1]
    v_pk_fma_f16 v17, v57, v59, v17 op_sel:[1,1,0] op_sel_hi:[1,0,1] neg_lo:[0,1,0]
    v_pk_mul_f16 v18, v58, v59 op_sel:[0,0] op_sel_hi:[0,1]
    v_pk_fma_f16 v18, v58, v59, v18 op_sel:[1,1,0] op_sel_hi:[1,0,1] neg_lo:[0,1,0]
    ds_write_addtid_b32 v56 offset:14112
    ds_write_addtid_b32 v57 offset:14400
    ds_write_addtid_b32 v58 offset:14688
    ds_write_addtid_b32 v59 offset:20736
    ds_write_addtid_b32 v16 offset:21024
    ds_write_addtid_b32 v17 offset:21312
    ds_write_addtid_b32 v18 offset:21600
    v_pk_mul_f32 v[38:39], v[36:37], v[36:37] op_sel:[0,0] op_sel_hi:[0,1]
    v_pk_fma_f32 v[36:37], v[36:37], v[36:37], v[38:39] op_sel:[1,1,0] op_sel_hi:[1,0,1] neg_lo:[0,1,0]
    v_cvt_pk_f16_f32 v19, v36, v37
    v_pk_mul_f16 v20, v28, v19 op_sel:[0,0] op_sel_hi:[0,1] neg_hi:[0,1]
    v_pk_fma_f16 v20, v28, v19, v20 op_sel:[1,1,0] op_sel_hi:[1,0,1]
    v_pk_mul_f32 v[38:39], v[36:37], v[36:37] op_sel:[0,0] op_sel_hi:[0,1]
    v_pk_fma_f32 v[36:37], v[36:37], v[36:37], v[38:39] op_sel:[1,1,0] op_sel_hi:[1,0,1] neg_lo:[0,1,0]
    v_cvt_pk_f16_f32 v21, v36, v37
    v_pk_mul_f16 v22, v28, v21 op_sel:[0,0] op_sel_hi:[0,1] neg_hi:[0,1]
    v_pk_fma_f16 v22, v28, v21, v22 op_sel:[1,1,0] op_sel_hi:[1,0,1]
    v_pk_mul_f16 v23, v20, v21 op_sel:[0,0] op_sel_hi:[0,1] neg_hi:[0,1]
    v_pk_fma_f16 v23, v20, v21, v23 op_sel:[1,1,0] op_sel_hi:[1,0,1]
    v_pk_mul_f32 v[38:39], v[36:37], v[36:37] op_sel:[0,0] op_sel_hi:[0,1]
    v_pk_fma_f32 v[36:37], v[36:37], v[36:37], v[38:39] op_sel:[1,1,0] op_sel_hi:[1,0,1] neg_lo:[0,1,0]
    v_cvt_pk_f16_f32 v24, v36, v37
    v_pk_mul_f16 v25, v28, v24 op_sel:[0,0] op_sel_hi:[0,1] neg_hi:[0,1]
    v_pk_fma_f16 v25, v28, v24, v25 op_sel:[1,1,0] op_sel_hi:[1,0,1]
    v_pk_mul_f16 v26, v20, v24 op_sel:[0,0] op_sel_hi:[0,1] neg_hi:[0,1]
    v_pk_fma_f16 v26, v20, v24, v26 op_sel:[1,1,0] op_sel_hi:[1,0,1]
    v_pk_mul_f16 v27, v22, v24 op_sel:[0,0] op_sel_hi:[0,1] neg_hi:[0,1]
    v_pk_fma_f16 v27, v22, v24, v27 op_sel:[1,1,0] op_sel_hi:[1,0,1]
    v_pk_mul_f16 v136, v23, v24 op_sel:[0,0] op_sel_hi:[0,1] neg_hi:[0,1]
    v_pk_fma_f16 v136, v23, v24, v136 op_sel:[1,1,0] op_sel_hi:[1,0,1]
    ds_write_addtid_b32 v28 offset:16128
    ds_write_addtid_b32 v20 offset:16416
    ds_write_addtid_b32 v22 offset:16704
    ds_write_addtid_b32 v23 offset:16992
    ds_write_addtid_b32 v25 offset:17280
    ds_write_addtid_b32 v26 offset:17568
    ds_write_addtid_b32 v27 offset:17856
    ds_write_addtid_b32 v136 offset:18144
    v_pk_mul_f32 v[38:39], v[36:37], v[36:37] op_sel:[0,0] op_sel_hi:[0,1]
    v_pk_fma_f32 v[36:37], v[36:37], v[36:37], v[38:39] op_sel:[1,1,0] op_sel_hi:[1,0,1] neg_lo:[0,1,0]
    v_cvt_pk_f16_f32 v137, v36, v37
    v_pk_mul_f16 v138, v28, v137 op_sel:[0,0] op_sel_hi:[0,1] neg_hi:[0,1]
    v_pk_fma_f16 v138, v28, v137, v138 op_sel:[1,1,0] op_sel_hi:[1,0,1]
    v_pk_mul_f16 v139, v20, v137 op_sel:[0,0] op_sel_hi:[0,1] neg_hi:[0,1]
    v_pk_fma_f16 v139, v20, v137, v139 op_sel:[1,1,0] op_sel_hi:[1,0,1]
    v_pk_mul_f16 v140, v22, v137 op_sel:[0,0] op_sel_hi:[0,1] neg_hi:[0,1]
    v_pk_fma_f16 v140, v22, v137, v140 op_sel:[1,1,0] op_sel_hi:[1,0,1]
    v_pk_mul_f16 v141, v23, v137 op_sel:[0,0] op_sel_hi:[0,1] neg_hi:[0,1]
    v_pk_fma_f16 v141, v23, v137, v141 op_sel:[1,1,0] op_sel_hi:[1,0,1]
    v_pk_mul_f16 v142, v25, v137 op_sel:[0,0] op_sel_hi:[0,1] neg_hi:[0,1]
    v_pk_fma_f16 v142, v25, v137, v142 op_sel:[1,1,0] op_sel_hi:[1,0,1]
    v_pk_mul_f16 v143, v26, v137 op_sel:[0,0] op_sel_hi:[0,1] neg_hi:[0,1]
    v_pk_fma_f16 v143, v26, v137, v143 op_sel:[1,1,0] op_sel_hi:[1,0,1]
    v_pk_mul_f16 v144, v27, v137 op_sel:[0,0] op_sel_hi:[0,1] neg_hi:[0,1]
    v_pk_fma_f16 v144, v27, v137, v144 op_sel:[1,1,0] op_sel_hi:[1,0,1]
    v_pk_mul_f16 v145, v136, v137 op_sel:[0,0] op_sel_hi:[0,1] neg_hi:[0,1]
    v_pk_fma_f16 v145, v136, v137, v145 op_sel:[1,1,0] op_sel_hi:[1,0,1]
    ds_write_addtid_b32 v138 offset:18432
    ds_write_addtid_b32 v139 offset:18720
    ds_write_addtid_b32 v140 offset:19008
    ds_write_addtid_b32 v141 offset:19296
    ds_write_addtid_b32 v142 offset:19584
    ds_write_addtid_b32 v143 offset:19872
    ds_write_addtid_b32 v144 offset:20160
    ds_write_addtid_b32 v145 offset:20448
    ds_read_b128 v[72:75], v42 offset:0
    ds_read_b128 v[76:79], v42 offset:64
    ds_read_b128 v[80:83], v42 offset:128
    ds_read_b128 v[84:87], v42 offset:192
    s_cmp_eq_u32 s54, 1
    s_cbranch_scc1 L_hook
L_hookback:
    v_pk_mul_f32 v[38:39], v[36:37], v[36:37] op_sel:[0,0] op_sel_hi:[0,1]
    v_pk_fma_f32 v[36:37], v[36:37], v[36:37], v[38:39] op_sel:[1,1,0] op_sel_hi:[1,0,1] neg_lo:[0,1,0]
    v_cvt_pk_f16_f32 v146, v36, v37
    v_pk_mul_f16 v147, v56, v146 op_sel:[0,0] op_sel_hi:[0,1]
    v_pk_fma_f16 v147, v56, v146, v147 op_sel:[1,1,0] op_sel_hi:[1,0,1] neg_lo:[0,1,0]
    v_pk_mul_f16 v148, v57, v146 op_sel:[0,0] op_sel_hi:[0,1]
    v_pk_fma_f16 v148, v57, v146, v148 op_sel:[1,1,0] op_sel_hi:[1,0,1] neg_lo:[0,1,0]
    v_pk_mul_f16 v149, v58, v146 op_sel:[0,0] op_sel_hi:[0,1]
    v_pk_fma_f16 v149, v58, v146, v149 op_sel:[1,1,0] op_sel_hi:[1,0,1] neg_lo:[0,1,0]
    v_pk_mul_f16 v150, v59, v146 op_sel:[0,0] op_sel_hi:[0,1]
    v_pk_fma_f16 v150, v59, v146, v150 op_sel:[1,1,0] op_sel_hi:[1,0,1] neg_lo:[0,1,0]
    v_pk_mul_f16 v151, v16, v146 op_sel:[0,0] op_sel_hi:[0,1]
    v_pk_fma_f16 v151, v16, v146, v151 op_sel:[1,1,0] op_sel_hi:[1,0,1] neg_lo:[0,1,0]
    v_pk_mul_f16 v152, v17, v146 op_sel:[0,0] op_sel_hi:[0,1]
    v_pk_fma_f16 v152, v17, v146, v152 op_sel:[1,1,0] op_sel_hi:[1,0,1] neg_lo:[0,1,0]
    v_pk_mul_f16 v153, v18, v146 op_sel:[0,0] op_sel_hi:[0,1]
    v_pk_fma_f16 v153, v18, v146, v153 op_sel:[1,1,0] op_sel_hi:[1,0,1] neg_lo:[0,1,0]
    v_pk_mul_f16 v154, v19, v146 op_sel:[0,0] op_sel_hi:[0,1]
    v_pk_fma_f16 v154, v19, v146, v154 op_sel:[1,1,0] op_sel_hi:[1,0,1] neg_lo:[0,1,0]
    ds_write_addtid_b32 v146 offset:16128
    ds_write_addtid_b32 v147 offset:16416
    ds_write_addtid_b32 v148 offset:16704
    ds_write_addtid_b32 v149 offset:16992
    ds_write_addtid_b32 v150 offset:18432
    ds_write_addtid_b32 v151 offset:18720
    ds_write_addtid_b32 v152 offset:19008
    ds_write_addtid_b32 v153 offset:19296
    v_pk_mul_f32 v[38:39], v[36:37], v[36:37] op_sel:[0,0] op_sel_hi:[0,1]
    v_pk_fma_f32 v[36:37], v[36:37], v[36:37], v[38:39] op_sel:[1,1,0] op_sel_hi:[1,0,1] neg_lo:[0,1,0]
    v_cvt_pk_f16_f32 v155, v36, v37
    v_pk_mul_f16 v156, v57, v155 op_sel:[0,0] op_sel_hi:[0,1]
    v_pk_fma_f16 v156, v57, v155, v156 op_sel:[1,1,0] op_sel_hi:[1,0,1] neg_lo:[0,1,0]
    v_pk_mul_f16 v157, v59, v155 op_sel:[0,0] op_sel_hi:[0,1]
    v_pk_fma_f16 v157, v59, v155, v157 op_sel:[1,1,0] op_sel_hi:[1,0,1] neg_lo:[0,1,0]
    v_pk_mul_f16 v158, v17, v155 op_sel:[0,0] op_sel_hi:[0,1]
    v_pk_fma_f16 v158, v17, v155, v158 op_sel:[1,1,0] op_sel_hi:[1,0,1] neg_lo:[0,1,0]
    v_pk_mul_f16 v159, v19, v155 op_sel:[0,0] op_sel_hi:[0,1]
    v_pk_fma_f16 v159, v19, v155, v159 op_sel:[1,1,0] op_sel_hi:[1,0,1] neg_lo:[0,1,0]
    v_pk_mul_f16 v160, v146, v155 op_sel:[0,0] op_sel_hi:[0,1]
    v_pk_fma_f16 v160, v146, v155, v160 op_sel:[1,1,0] op_sel_hi:[1,0,1] neg_lo:[0,1,0]
    v_pk_mul_f16 v161, v148, v155 op_sel:[0,0] op_sel_hi:[0,1]
    v_pk_fma_f16 v161, v148, v155, v161 op_sel:[1,1,0] op_sel_hi:[1,0,1] neg_lo:[0,1,0]
    v_pk_mul_f16 v162, v150, v155 op_sel:[0,0] op_sel_hi:[0,1]
    v_pk_fma_f16 v162, v150, v155, v162 op_sel:[1,1,0] op_sel_hi:[1,0,1] neg_lo:[0,1,0]
    v_pk_mul_f16 v163, v152, v155 op_sel:[0,0] op_sel_hi:[0,1]
    v_pk_fma_f16 v163, v152, v155, v163 op_sel:[1,1,0] op_sel_hi:[1,0,1] neg_lo:[0,1,0]
    v_pk_mul_f16 v21, v154, v155 op_sel:[0,0] op_sel_hi:[0,1]
    v_pk_fma_f16 v21, v154, v155, v21 op_sel:[1,1,0] op_sel_hi:[1,0,1] neg_lo:[0,1,0]
    v_pk_mul_f32 v[38:39], v[36:37], v[36:37] op_sel:[0,0] op_sel_hi:[0,1]
    v_pk_fma_f32 v[36:37], v[36:37], v[36:37], v[38:39] op_sel:[1,1,0] op_sel_hi:[1,0,1] neg_lo:[0,1,0]
    v_cvt_pk_f16_f32 v24, v36, v37
    v_pk_mul_f32 v[38:39], v[36:37], v[36:37] op_sel:[0,0] op_sel_hi:[0,1]
    v_pk_fma_f32 v[36:37], v[36:37], v[36:37], v[38:39] op_sel:[1,1,0] op_sel_hi:[1,0,1] neg_lo:[0,1,0]
    v_cvt_pk_f16_f32 v137, v36, v37
    ds_write_addtid_b32 v155 offset:17280
    ds_write_addtid_b32 v156 offset:17568
    ds_write_addtid_b32 v157 offset:17856
    ds_write_addtid_b32 v158 offset:18144
    ds_write_addtid_b32 v159 offset:19584
    ds_write_addtid_b32 v160 offset:14976
    ds_write_addtid_b32 v161 offset:15264
    ds_write_addtid_b32 v162 offset:15552
    ds_write_addtid_b32 v163 offset:15840
    ds_write_addtid_b32 v21 offset:19872
    ds_read_b128 v[88:91], v40 offset:0
    ds_read_b128 v[92:95], v40 offset:64
    ds_read_b128 v[96:99], v40 offset:128
    ds_read_b128 v[100:103], v40 offset:192
    v_pk_mul_f16 v20, v59, v24 op_sel:[0,0] op_sel_hi:[0,1]
    v_pk_fma_f16 v20, v59, v24, v20 op_sel:[1,1,0] op_sel_hi:[1,0,1] neg_lo:[0,1,0]
    v_pk_mul_f16 v22, v150, v24 op_sel:[0,0] op_sel_hi:[0,1]
    v_pk_fma_f16 v22, v150, v24, v22 op_sel:[1,1,0] op_sel_hi:[1,0,1] neg_lo:[0,1,0]
    ds_read_b128 v[104:107], v41 offset:0
    ds_read_b128 v[108:111], v41 offset:64
    ds_read_b128 v[112:115], v41 offset:128
    ds_read_b128 v[116:119], v41 offset:192
    v_pk_mul_f16 v23, v157, v24 op_sel:[0,0] op_sel_hi:[0,1]
    v_pk_fma_f16 v23, v157, v24, v23 op_sel:[1,1,0] op_sel_hi:[1,0,1] neg_lo:[0,1,0]
    v_pk_mul_f16 v25, v162, v24 op_sel:[0,0] op_sel_hi:[0,1]
    v_pk_fma_f16 v25, v162, v24, v25 op_sel:[1,1,0] op_sel_hi:[1,0,1] neg_lo:[0,1,0]
    s_waitcnt lgkmcnt(4)
    s_nop 0
    v_pk_mul_f16 v26, v19, v24 op_sel:[0,0] op_sel_hi:[0,1]
    v_pk_fma_f16 v26, v19, v24, v26 op_sel:[1,1,0] op_sel_hi:[1,0,1] neg_lo:[0,1,0]
    v_mfma_f32_16x16x32_f16 v[60:63], v[88:91], v[72:75], v[60:63]
    v_pk_mul_f16 v27, v154, v24 op_sel:[0,0] op_sel_hi:[0,1]
    v_pk_fma_f16 v27, v154, v24, v27 op_sel:[1,1,0] op_sel_hi:[1,0,1] neg_lo:[0,1,0]
    v_mfma_f32_16x16x32_f16 v[60:63], v[92:95], v[76:79], v[60:63]
    v_pk_mul_f16 v136, v159, v24 op_sel:[0,0] op_sel_hi:[0,1]
    v_pk_fma_f16 v136, v159, v24, v136 op_sel:[1,1,0] op_sel_hi:[1,0,1] neg_lo:[0,1,0]
    v_mfma_f32_16x16x32_f16 v[60:63], v[96:99], v[80:83], v[60:63]
    v_pk_mul_f16 v138, v21, v24 op_sel:[0,0] op_sel_hi:[0,1]
    v_pk_fma_f16 v138, v21, v24, v138 op_sel:[1,1,0] op_sel_hi:[1,0,1] neg_lo:[0,1,0]
    v_mfma_f32_16x16x32_f16 v[60:63], v[100:103], v[84:87], v[60:63]
    ds_write_addtid_b32 v20 offset:16128
    ds_write_addtid_b32 v22 offset:16416
    ds_write_addtid_b32 v23 offset:16704
    ds_write_addtid_b32 v25 offset:16992
    ds_write_addtid_b32 v26 offset:17280
    ds_write_addtid_b32 v27 offset:17568
    ds_write_addtid_b32 v136 offset:17856
    ds_write_addtid_b32 v138 offset:18144
    s_waitcnt lgkmcnt(8)
    s_nop 0
    v_pk_mul_f16 v139, v19, v137 op_sel:[0,0] op_sel_hi:[0,1]
    v_pk_fma_f16 v139, v19, v137, v139 op_sel:[1,1,0] op_sel_hi:[1,0,1] neg_lo:[0,1,0]
    v_pk_mul_f16 v140, v154, v137 op_sel:[0,0] op_sel_hi:[0,1]
    v_pk_fma_f16 v140, v154, v137, v140 op_sel:[1,1,0] op_sel_hi:[1,0,1] neg_lo:[0,1,0]
    v_mfma_f32_16x16x32_f16 v[64:67], v[104:107], v[72:75], v[64:67]
    v_pk_mul_f16 v141, v159, v137 op_sel:[0,0] op_sel_hi:[0,1]
    v_pk_fma_f16 v141, v159, v137, v141 op_sel:[1,1,0] op_sel_hi:[1,0,1] neg_lo:[0,1,0]
    v_pk_mul_f16 v142, v21, v137 op_sel:[0,0] op_sel_hi:[0,1]
    v_pk_fma_f16 v142, v21, v137, v142 op_sel:[1,1,0] op_sel_hi:[1,0,1] neg_lo:[0,1,0]
    v_mfma_f32_16x16x32_f16 v[64:67], v[108:111], v[76:79], v[64:67]
    v_pk_mul_f16 v143, v26, v137 op_sel:[0,0] op_sel_hi:[0,1]
    v_pk_fma_f16 v143, v26, v137, v143 op_sel:[1,1,0] op_sel_hi:[1,0,1] neg_lo:[0,1,0]
    v_pk_mul_f16 v144, v27, v137 op_sel:[0,0] op_sel_hi:[0,1]
    v_pk_fma_f16 v144, v27, v137, v144 op_sel:[1,1,0] op_sel_hi:[1,0,1] neg_lo:[0,1,0]
    v_mfma_f32_16x16x32_f16 v[64:67], v[112:115], v[80:83], v[64:67]
    v_pk_mul_f16 v145, v136, v137 op_sel:[0,0] op_sel_hi:[0,1]
    v_pk_fma_f16 v145, v136, v137, v145 op_sel:[1,1,0] op_sel_hi:[1,0,1] neg_lo:[0,1,0]
    v_pk_mul_f16 v56, v138, v137 op_sel:[0,0] op_sel_hi:[0,1]
    v_pk_fma_f16 v56, v138, v137, v56 op_sel:[1,1,0] op_sel_hi:[1,0,1] neg_lo:[0,1,0]
    v_mfma_f32_16x16x32_f16 v[64:67], v[116:119], v[84:87], v[64:67]
    ds_write_addtid_b32 v139 offset:18432
    ds_write_addtid_b32 v140 offset:18720
    ds_write_addtid_b32 v141 offset:19008
    ds_write_addtid_b32 v142 offset:19296
    ds_write_addtid_b32 v143 offset:19584
    ds_write_addtid_b32 v144 offset:19872
    ds_write_addtid_b32 v145 offset:20160
    ds_write_addtid_b32 v56 offset:20448
    ds_read_b128 v[88:91], v42 offset:0
    ds_read_b128 v[92:95], v42 offset:64
    ds_read_b128 v[96:99], v42 offset:128
    ds_read_b128 v[100:103], v42 offset:192
    s_sub_u32 s53, s53, 1
    s_or_b32 s48, s53, s54
    s_cbranch_scc0 L_last
    v_exp_f32 v38, v12
    v_cos_f32 v36, v13
    v_sin_f32 v37, v13
    v_mov_b32 v28, v29
    v_mov_b32 v29, v30
    v_pk_mov_b32 v[12:13], v[14:15], v[14:15] op_sel:[0,1]
    v_pk_mul_f32 v[36:37], v[36:37], v[38:39] op_sel:[0,0] op_sel_hi:[1,0]
    s_waitcnt lgkmcnt(3)
    v_mfma_f32_16x16x32_f16 v[68:71], v[72:75], v[88:91], v[68:71]
    s_waitcnt lgkmcnt(2)
    v_mfma_f32_16x16x32_f16 v[68:71], v[76:79], v[92:95], v[68:71]
    s_waitcnt lgkmcnt(1)
    v_mfma_f32_16x16x32_f16 v[68:71], v[80:83], v[96:99], v[68:71]
    s_waitcnt lgkmcnt(0)
    v_mfma_f32_16x16x32_f16 v[68:71], v[84:87], v[100:103], v[68:71]
    s_cmp_eq_u32 s54, 1
    s_cbranch_scc1 L_zend
    s_cmp_eq_u32 s53, s68
    s_cbranch_scc0 L_pass
    s_setprio 1
    s_branch L_pass
L_zend:
    s_nop 4
    v_mov_b32 v7, 1
    v_mul_f32 v104, v31, v60
    v_mul_f32 v105, v31, v61
    v_mul_f32 v106, v31, v62
    v_mul_f32 v107, v31, v63
    v_mul_f32 v108, v31, v64
    v_mul_f32 v109, v31, v65
    v_mul_f32 v110, v31, v66
    v_mul_f32 v111, v31, v67
    v_mul_f32 v112, v31, v68
    v_mul_f32 v113, v31, v69
    v_mul_f32 v114, v31, v70
    v_mul_f32 v115, v31, v71
    ds_write_b128 v48, v[104:107] offset:0
    ds_write_b128 v48, v[108:111] offset:1024
    ds_write_b128 v48, v[112:115] offset:2048
    ds_write_b32 v49, v7
    s_cmp_eq_u32 s53, 0
    s_cbranch_scc1 L_zpost
    v_add_u32 v48, 3072, v48
    v_add_u32 v49, 4, v49
    v_mov_b32 v31, v32
    v_mov_b32 v60, 0
    v_mov_b32 v61, 0
    v_pk_mov_b32 v[62:63], v[60:61], v[60:61]
    v_pk_mov_b32 v[64:65], v[60:61], v[60:61]
    v_pk_mov_b32 v[66:67], v[60:61], v[60:61]
    v_pk_mov_b32 v[68:69], v[60:61], v[60:61]
    v_pk_mov_b32 v[70:71], v[60:61], v[60:61]
    v_add_u32 v46, 163840, v46
    global_load_dwordx2 v[184:185], v46, s[4:5]
    global_load_dwordx2 v[186:187], v46, s[4:5] offset:1280
    v_add_u32 v46, 163840, v46
    global_load_dwordx2 v[188:189], v46, s[4:5]
    global_load_dwordx2 v[190:191], v46, s[4:5] offset:1280
    s_branch L_pass
L_last:
    s_cmp_eq_u32 s68, 1
    s_cbranch_scc1 L_fF
    s_setprio 0
L_zget:
    ds_read_b32 v8, v49
    ds_read_b128 v[104:107], v48 offset:0
    ds_read_b128 v[108:111], v48 offset:1024
    ds_read_b128 v[112:115], v48 offset:2048
    s_waitcnt lgkmcnt(0)
    v_cmp_eq_u32 vcc, 0, v8
    s_cbranch_vccz L_fW
L_zpoll:
    s_sub_u32 s75, s75, 1
    s_cbranch_scc1 L_end
    s_sleep 2
    ds_read_b32 v8, v49
    s_waitcnt lgkmcnt(0)
    v_cmp_eq_u32 vcc, 0, v8
    s_cbranch_vccnz L_zpoll
    s_branch L_zget
L_fF:
    v_mov_b32 v104, 0
    v_mov_b32 v105, 0
    v_pk_mov_b32 v[106:107], v[104:105], v[104:105]
    v_pk_mov_b32 v[108:109], v[104:105], v[104:105]
    v_pk_mov_b32 v[110:111], v[104:105], v[104:105]
    v_pk_mov_b32 v[112:113], v[104:105], v[104:105]
    v_pk_mov_b32 v[114:115], v[104:105], v[104:105]
L_fW:
    s_mov_b64 exec, 1
    v_add_f32 v104, s62, v104
    s_mov_b64 exec, -1
    v_fma_f32 v60, v31, v60, v104
    v_fma_f32 v61, v31, v61, v105
    v_fma_f32 v62, v31, v62, v106
    v_fma_f32 v63, v31, v63, v107
    v_fma_f32 v64, v31, v64, v108
    v_fma_f32 v65, v31, v65, v109
    v_fma_f32 v66, v31, v66, v110
    v_fma_f32 v67, v31, v67, v111
    v_cvt_pk_bf16_f32 v136, v67, v66
    v_cvt_pk_bf16_f32 v137, v65, v64
    v_cvt_pk_bf16_f32 v138, v63, v62
    v_cvt_pk_bf16_f32 v139, v61, v60
    s_waitcnt lgkmcnt(0)
    v_mfma_f32_16x16x32_f16 v[68:71], v[72:75], v[88:91], v[68:71]
    ds_write_b128 v43, v[136:139]
    v_mfma_f32_16x16x32_f16 v[68:71], v[76:79], v[92:95], v[68:71]
    v_mov_b32_dpp v140, v136 wave_shr:1 row_mask:0xf bank_mask:0xf bound_ctrl:0
    v_mov_b32_dpp v141, v137 wave_shr:1 row_mask:0xf bank_mask:0xf bound_ctrl:0
    v_mfma_f32_16x16x32_f16 v[68:71], v[80:83], v[96:99], v[68:71]
    v_alignbit_b32 v144, v137, v136, 16
    v_alignbit_b32 v145, v138, v137, 16
    v_mfma_f32_16x16x32_f16 v[68:71], v[84:87], v[100:103], v[68:71]
    v_alignbit_b32 v146, v139, v138, 16
    v_alignbit_b32 v147, v140, v139, 16
    v_alignbit_b32 v152, v138, v137, 16
    v_alignbit_b32 v153, v139, v138, 16
    v_alignbit_b32 v154, v140, v139, 16
    v_alignbit_b32 v155, v141, v140, 16
    v_mov_b32 v148, v137
    v_mov_b32 v149, v138
    v_mov_b32 v150, v139
    v_mov_b32 v151, v140
    v_readlane_b32 s48, v136, 63
    v_readlane_b32 s49, v137, 63
    ds_write_b128 v43, v[144:147] offset:1984
    ds_write_b128 v43, v[148:151] offset:3968
    ds_write_b128 v43, v[152:155] offset:5952
    v_fma_f32 v68, v31, v68, v112
    v_fma_f32 v69, v31, v69, v113
    v_fma_f32 v70, v31, v70, v114
    v_fma_f32 v71, v31, v71, v115
    v_cvt_pk_bf16_f32 v156, v71, v70
    v_cvt_pk_bf16_f32 v157, v69, v68
    s_lshr_b32 s51, s48, 16
    v_readlane_b32 s50, v156, 55
    ds_write_b64 v44, v[156:157] offset:12
    ds_write_b32 v44, v156 offset:1992
    ds_write_b32 v44, v157 offset:1996
    ds_write_b64 v44, v[156:157] offset:3972
    ds_write_b32 v44, v156 offset:5952
    ds_write_b32 v44, v157 offset:5956
    v_mov_b32 v5, s50
    s_mov_b64 exec, 0xffffff
    v_mov_b32 v5, s49
    s_mov_b64 exec, 0xfffff
    v_mov_b32 v5, s51
    s_mov_b64 exec, 0xffff
    v_mov_b32 v5, s48
    s_mov_b32 exec_lo, -1
    ds_write_b16 v45, v5
    s_mov_b64 exec, -1
    s_branch L_nostage
L_zpost:
    s_setprio 0
    s_lshl_b32 s48, s52, 11
    s_mov_b32 m0, s48
    s_and_b32 s50, s47, 1
    s_mul_i32 s48, s50, 0x02020202
    s_add_u32 s48, s48, 0x05040100
    s_xor_b32 s49, s48, 0x02020202
    s_cmp_eq_u32 s3, 6
    s_cbranch_scc0 L_nosw0
    v_add_u32 v9, 4096, v47
    global_load_dwordx4 v[212:215], v47, s[42:43] offset:0 sc1
    global_load_dwordx4 v[216:219], v47, s[42:43] offset:1024 sc1
    global_load_dwordx4 v[220:223], v47, s[42:43] offset:2048 sc1
    global_load_dwordx4 v[224:227], v47, s[42:43] offset:3072 sc1
    global_load_dwordx4 v[228:231], v9, s[42:43] offset:0 sc1
    global_load_dwordx4 v[232:235], v9, s[42:43] offset:1024 sc1
    global_load_dwordx4 v[236:239], v9, s[42:43] offset:2048 sc1
    global_load_dwordx4 v[240:243], v9, s[42:43] offset:3072 sc1
    s_waitcnt vmcnt(16)
    s_branch L_sw20
L_nosw0:
    v_mov_b32 v5, 0
    ds_write_addtid_b32 v5 offset:0
    ds_write_addtid_b32 v5 offset:256
    ds_write_addtid_b32 v5 offset:4608
    ds_write_addtid_b32 v5 offset:4864
    ds_write_addtid_b32 v5 offset:9216
    ds_write_addtid_b32 v5 offset:9472
    s_waitcnt vmcnt(8)
L_sw20:
    s_cmp_eq_u32 s50, 0
    v_perm_b32 v12, v166, v164, s48
    v_perm_b32 v14, v167, v165, s48
    v_perm_b32 v15, v170, v168, s48
    v_perm_b32 v17, v171, v169, s48
    v_perm_b32 v18, v174, v172, s48
    v_perm_b32 v20, v175, v173, s48
    v_perm_b32 v21, v178, v176, s48
    v_perm_b32 v23, v179, v177, s48
    s_cbranch_scc1 L_usel00
    v_perm_b32 v13, v167, v165, s49
    v_perm_b32 v16, v171, v169, s49
    v_perm_b32 v19, v175, v173, s49
    v_perm_b32 v22, v179, v177, s49
    s_branch L_usel10
L_usel00:
    v_perm_b32 v13, v166, v164, s49
    v_perm_b32 v16, v170, v168, s49
    v_perm_b32 v19, v174, v172, s49
    v_perm_b32 v22, v178, v176, s49
L_usel10:
    ds_write_addtid_b32 v12 offset:512
    ds_write_addtid_b32 v13 offset:5120
    ds_write_addtid_b32 v14 offset:9728
    ds_write_addtid_b32 v15 offset:768
    ds_write_addtid_b32 v16 offset:5376
    ds_write_addtid_b32 v17 offset:9984
    ds_write_addtid_b32 v18 offset:1024
    ds_write_addtid_b32 v19 offset:5632
    ds_write_addtid_b32 v20 offset:10240
    ds_write_addtid_b32 v21 offset:1280
    ds_write_addtid_b32 v22 offset:5888
    ds_write_addtid_b32 v23 offset:10496
    s_cmp_eq_u32 s3, 6
    s_cbranch_scc0 L_nosw1
    s_waitcnt vmcnt(8)
    s_branch L_sw21
L_nosw1:
    s_waitcnt vmcnt(0)
L_sw21:
    s_cmp_eq_u32 s50, 0
    v_perm_b32 v24, v182, v180, s48
    v_perm_b32 v26, v183, v181, s48
    v_perm_b32 v27, v186, v184, s48
    v_perm_b32 v29, v187, v185, s48
    v_perm_b32 v30, v190, v188, s48
    v_perm_b32 v32, v191, v189, s48
    v_perm_b32 v33, v194, v192, s48
    v_perm_b32 v35, v195, v193, s48
    s_cbranch_scc1 L_usel01
    v_perm_b32 v25, v183, v181, s49
    v_perm_b32 v28, v187, v185, s49
    v_perm_b32 v31, v191, v189, s49
    v_perm_b32 v34, v195, v193, s49
    s_branch L_usel11
L_usel01:
    v_perm_b32 v25, v182, v180, s49
    v_perm_b32 v28, v186, v184, s49
    v_perm_b32 v31, v190, v188, s49
    v_perm_b32 v34, v194, v192, s49
L_usel11:
    ds_write_addtid_b32 v24 offset:1536
    ds_write_addtid_b32 v25 offset:6144
    ds_write_addtid_b32 v26 offset:10752
    ds_write_addtid_b32 v27 offset:1792
    ds_write_addtid_b32 v28 offset:6400
    ds_write_addtid_b32 v29 offset:11008
    ds_write_addtid_b32 v30 offset:2048
    ds_write_addtid_b32 v31 offset:6656
    ds_write_addtid_b32 v32 offset:11264
    ds_write_addtid_b32 v33 offset:2304
    ds_write_addtid_b32 v34 offset:6912
    ds_write_addtid_b32 v35 offset:11520
    s_cmp_eq_u32 s3, 6
    s_cbranch_scc0 L_nostage
    v_add_u32 v7, 139520, v47
    v_mov_b32 v4, 0xffff0000
    v_mov_b32 v6, 78344
    s_waitcnt vmcnt(6)
    v_xor_b32 v5, s55, v213
    v_bitop3_b32 v5, v5, s55, v215 bitop3:0xf6
    v_bitop3_b32 v5, v5, s55, v217 bitop3:0xf6
    v_bitop3_b32 v5, v5, s55, v219 bitop3:0xf6
    v_cmp_ne_u32 vcc, 0, v5
    s_cbranch_vccnz L_gbad
    v_and_b32 v213, v4, v212
    v_lshlrev_b32 v212, 16, v212
    v_and_b32 v215, v4, v214
    v_lshlrev_b32 v214, 16, v214
    v_and_b32 v217, v4, v216
    v_lshlrev_b32 v216, 16, v216
    v_and_b32 v219, v4, v218
    v_lshlrev_b32 v218, 16, v218
    v_mov_b32 v2, 2
    v_mov_b32 v3, 2
    ds_write_b128 v7, v[212:215] offset:0
    ds_write_b128 v7, v[216:219] offset:1024
    ds_write_b64 v6, v[2:3]
    s_waitcnt lgkmcnt(0)
    s_barrier
    s_waitcnt vmcnt(0)
L_grest:
    v_xor_b32 v5, s55, v221
    v_bitop3_b32 v5, v5, s55, v223 bitop3:0xf6
    v_bitop3_b32 v5, v5, s55, v225 bitop3:0xf6
    v_bitop3_b32 v5, v5, s55, v227 bitop3:0xf6
    v_bitop3_b32 v5, v5, s55, v229 bitop3:0xf6
    v_bitop3_b32 v5, v5, s55, v231 bitop3:0xf6
    v_bitop3_b32 v5, v5, s55, v233 bitop3:0xf6
    v_bitop3_b32 v5, v5, s55, v235 bitop3:0xf6
    v_bitop3_b32 v5, v5, s55, v237 bitop3:0xf6
    v_bitop3_b32 v5, v5, s55, v239 bitop3:0xf6
    v_bitop3_b32 v5, v5, s55, v241 bitop3:0xf6
    v_bitop3_b32 v5, v5, s55, v243 bitop3:0xf6
    v_cmp_ne_u32 vcc, 0, v5
    s_cbranch_vccnz L_gagain
    v_and_b32 v221, v4, v220
    v_lshlrev_b32 v220, 16, v220
    v_and_b32 v223, v4, v222
    v_lshlrev_b32 v222, 16, v222
    v_and_b32 v225, v4, v224
    v_lshlrev_b32 v224, 16, v224
    v_and_b32 v227, v4, v226
    v_lshlrev_b32 v226, 16, v226
    v_and_b32 v229, v4, v228
    v_lshlrev_b32 v228, 16, v228
    v_and_b32 v231, v4, v230
    v_lshlrev_b32 v230, 16, v230
    v_and_b32 v233, v4, v232
    v_lshlrev_b32 v232, 16, v232
    v_and_b32 v235, v4, v234
    v_lshlrev_b32 v234, 16, v234
    v_and_b32 v237, v4, v236
    v_lshlrev_b32 v236, 16, v236
    v_and_b32 v239, v4, v238
    v_lshlrev_b32 v238, 16, v238
    v_and_b32 v241, v4, v240
    v_lshlrev_b32 v240, 16, v240
    v_and_b32 v243, v4, v242
    v_lshlrev_b32 v242, 16, v242
    v_mov_b32 v2, 64
    v_mov_b32 v3, 64
    ds_write_b128 v7, v[220:223] offset:2048
    ds_write_b128 v7, v[224:227] offset:3072
    ds_write_b128 v7, v[228:231] offset:4096
    ds_write_b128 v7, v[232:235] offset:5120
    ds_write_b128 v7, v[236:239] offset:6144
    ds_write_b128 v7, v[240:243] offset:7168
    ds_write_b64 v6, v[2:3]
    s_branch L_fin
L_gbad:
    s_waitcnt lgkmcnt(0)
    s_barrier
L_gagain:
    s_setprio 3
    s_sub_u32 s75, s75, 1
    s_cbranch_scc1 L_end
    s_waitcnt vmcnt(0) lgkmcnt(0)
    v_add_u32 v9, 4096, v47
    global_load_dwordx4 v[212:215], v47, s[42:43] offset:0 sc1
    global_load_dwordx4 v[216:219], v47, s[42:43] offset:1024 sc1
    global_load_dwordx4 v[220:223], v47, s[42:43] offset:2048 sc1
    global_load_dwordx4 v[224:227], v47, s[42:43] offset:3072 sc1
    global_load_dwordx4 v[228:231], v9, s[42:43] offset:0 sc1
    global_load_dwordx4 v[232:235], v9, s[42:43] offset:1024 sc1
    global_load_dwordx4 v[236:239], v9, s[42:43] offset:2048 sc1
    global_load_dwordx4 v[240:243], v9, s[42:43] offset:3072 sc1
    s_waitcnt vmcnt(0)
    v_xor_b32 v5, s55, v213
    v_bitop3_b32 v5, v5, s55, v215 bitop3:0xf6
    v_bitop3_b32 v5, v5, s55, v217 bitop3:0xf6
    v_bitop3_b32 v5, v5, s55, v219 bitop3:0xf6
    v_cmp_ne_u32 vcc, 0, v5
    s_cbranch_vccnz L_gagain
    v_and_b32 v213, v4, v212
    v_lshlrev_b32 v212, 16, v212
    v_and_b32 v215, v4, v214
    v_lshlrev_b32 v214, 16, v214
    v_and_b32 v217, v4, v216
    v_lshlrev_b32 v216, 16, v216
    v_and_b32 v219, v4, v218
    v_lshlrev_b32 v218, 16, v218
    v_mov_b32 v2, 2
    v_mov_b32 v3, 2
    ds_write_b128 v7, v[212:215] offset:0
    ds_write_b128 v7, v[216:219] offset:1024
    ds_write_b64 v6, v[2:3]
    s_branch L_grest
L_nostage:
    s_waitcnt vmcnt(0)
    s_cmp_lt_u32 s3, 3
    s_cbranch_scc1 L_main
    s_cmp_eq_u32 s68, 1
    s_cbranch_scc0 L_far
L_store:
    s_waitcnt lgkmcnt(0)
    s_barrier
    s_setprio 3
    s_mov_b32 s100, 7
    s_bitcmp1_b32 2098176, s46
    s_cselect_b32 s100, 6, s100
    s_cmp_eq_u32 s46, 27
    s_cselect_b32 s100, 4, s100
    s_brev_b32 s48, s100
    s_lshr_b32 s48, s48, 29
    s_bitcmp1_b32 s44, 0
    s_cselect_b32 s100, s48, s100
    s_mov_b32 s64, s38
    s_mov_b32 s65, s39
    s_mov_b32 s66, 2621440
    s_mov_b32 s67, 0x20000
    s_lshl_b32 s49, s47, 1
    v_add_u32_sdwa v7, v246, s49 dst_sel:DWORD dst_unused:UNUSED_PAD src0_sel:WORD_0 src1_sel:DWORD
    s_and_b32 s48, s3, 1
    s_lshl_b32 s49, s48, 7
    s_add_u32 s49, s49, 78592
    v_add_u32_sdwa v8, v246, s49 dst_sel:DWORD dst_unused:UNUSED_PAD src0_sel:WORD_1 src1_sel:DWORD
    s_mov_b32 s49, 82688
    v_add_u32_sdwa v9, v247, s49 dst_sel:DWORD dst_unused:UNUSED_PAD src0_sel:WORD_0 src1_sel:DWORD
    v_add_u32 v10, 64, v8
    s_mul_i32 s73, s48, 163840
    s_mov_b32 s72, 0
    s_mul_i32 s48, s100, 0x11111111
    s_mov_b32 exec_lo, s48
    s_mov_b32 exec_hi, s48
    s_mov_b64 vcc, exec
L_swait:
    s_sub_u32 s75, s75, 1
    s_cbranch_scc1 L_end
    s_cmp_eq_u64 vcc, exec
    s_cbranch_scc0 L_sloop
    s_sleep 16
L_sloop:
    ds_read_b32 v12, v9
    s_waitcnt lgkmcnt(0)
    v_cmp_ge_u32 vcc, s72, v12
    s_cbranch_vccnz L_swait
    ds_read2st64_b32 v[16:17], v8 offset0:0 offset1:1
    ds_read2st64_b32 v[18:19], v10 offset0:0 offset1:1
    s_waitcnt lgkmcnt(1)
    buffer_store_short v16, v7, s[64:67], s73 offen
    s_add_u32 s73, s73, 20480
    buffer_store_short_d16_hi v16, v7, s[64:67], s73 offen
    s_add_u32 s73, s73, 20480
    buffer_store_short v17, v7, s[64:67], s73 offen
    s_add_u32 s73, s73, 20480
    buffer_store_short_d16_hi v17, v7, s[64:67], s73 offen
    s_add_u32 s73, s73, 20480
    s_waitcnt lgkmcnt(0)
    buffer_store_short v18, v7, s[64:67], s73 offen
    s_add_u32 s73, s73, 20480
    buffer_store_short_d16_hi v18, v7, s[64:67], s73 offen
    s_add_u32 s73, s73, 20480
    buffer_store_short v19, v7, s[64:67], s73 offen
    s_add_u32 s73, s73, 20480
    buffer_store_short_d16_hi v19, v7, s[64:67], s73 offen
    s_add_u32 s73, s73, 184320
    v_add_u32 v8, 512, v8
    v_add_u32 v10, 512, v10
    s_add_u32 s72, s72, 1
    s_cmp_lt_u32 s72, 8
    s_cbranch_scc1 L_sloop
    s_mov_b64 exec, -1
    s_branch L_fin
L_light:
    s_lshl3_add_u32 s58, s2, s3
    s_and_b32 s51, s58, 15
    s_bfe_u32 s49, s58, 0x20004
    s_lshr_b32 s48, s58, 6
    s_lshl3_add_u32 s49, s48, s49
    s_lshl_b32 s49, s49, 6
    s_add_u32 s51, s51, s49
    v_lshrrev_b32 v8, 5, v0
    v_bfe_u32 v7, v0, 3, 2
    v_lshl_add_u32 v2, v8, 4, v7
    v_lshl_add_u32 v2, v2, 4, s51
    v_mul_u32_u24 v2, 1280, v2
    v_and_b32 v7, 7, v0
    v_lshlrev_b32 v7, 4, v7
    v_add_u32 v2, v2, v7
    s_lshl_b32 s49, s3, 8
    v_lshl_add_u32 v3, v0, 2, s49
    v_min_u32 v3, 1276, v3
    s_waitcnt lgkmcnt(0)
    global_load_dword v4, v3, s[36:37]
    s_load_dword s55, s[42:43], 8448
L_light2:
    s_cmp_lt_u32 s3, 6
    s_cbranch_scc1 L_lnopf
    s_and_b32 s49, s3, 1
    s_lshl1_add_u32 s50, s45, s49
    s_mul_i32 s50, s50, 40960
    s_mul_i32 s49, s44, 160
    s_add_u32 s50, s50, s49
    v_lshrrev_b32 v5, 1, v0
    v_mul_u32_u24 v5, 1280, v5
    v_and_b32 v6, 1, v0
    v_mul_u32_u24 v6, 156, v6
    v_add3_u32 v5, v5, v6, s50
    global_load_dword v50, v5, s[4:5]
L_lnopf:
    s_lshl_b32 s48, s48, 7
    s_and_b32 s49, s58, 63
    s_add_u32 s48, s48, s49
    s_lshl_b32 s48, s48, 4
    v_bfe_u32 v9, v0, 4, 1
    v_lshl_add_u32 v8, v8, 7, v9
    v_lshl_add_u32 v8, v8, 3, s48
    s_waitcnt vmcnt(1)
    s_cmp_lt_u32 s3, 6
    s_cbranch_scc0 L_lw
    s_waitcnt vmcnt(0)
L_lw:
    global_load_dwordx4 v[72:75], v2, s[4:5] offset:0
    global_load_dwordx4 v[76:79], v2, s[4:5] offset:128
    global_load_dwordx4 v[80:83], v2, s[4:5] offset:256
    global_load_dwordx4 v[84:87], v2, s[4:5] offset:384
    global_load_dwordx4 v[88:91], v2, s[4:5] offset:512
    global_load_dwordx4 v[92:95], v2, s[4:5] offset:640
    global_load_dwordx4 v[96:99], v2, s[4:5] offset:768
    global_load_dwordx4 v[100:103], v2, s[4:5] offset:896
    global_load_dwordx4 v[104:107], v2, s[4:5] offset:1024
    global_load_dwordx4 v[108:111], v2, s[4:5] offset:1152
    ds_write_b32 v3, v4
    s_waitcnt lgkmcnt(0)
    s_barrier
    ds_read_b128 v[112:115], v7 offset:0
    ds_read_b128 v[116:119], v7 offset:128
    ds_read_b128 v[120:123], v7 offset:256
    ds_read_b128 v[124:127], v7 offset:384
    ds_read_b128 v[128:131], v7 offset:512
    ds_read_b128 v[132:135], v7 offset:640
    ds_read_b128 v[136:139], v7 offset:768
    ds_read_b128 v[140:143], v7 offset:896
    ds_read_b128 v[144:147], v7 offset:1024
    ds_read_b128 v[148:151], v7 offset:1152
    s_add_u32 s55, s55, 0x9E3779B9
    s_mov_b32 s48, 0x80008000
    v_mov_b32 v3, 0
    v_mov_b32 v4, 0
    v_mov_b32 v7, s55
    s_waitcnt lgkmcnt(0)
    s_waitcnt vmcnt(9)
    v_dot2_f32_bf16 v3, v72, v112, v3
    v_dot2_f32_bf16 v4, v73, v113, v4
    v_dot2_f32_bf16 v3, v74, v114, v3
    v_dot2_f32_bf16 v4, v75, v115, v4
    s_waitcnt vmcnt(8)
    v_dot2_f32_bf16 v3, v76, v116, v3
    v_dot2_f32_bf16 v4, v77, v117, v4
    v_dot2_f32_bf16 v3, v78, v118, v3
    v_dot2_f32_bf16 v4, v79, v119, v4
    s_waitcnt vmcnt(7)
    v_dot2_f32_bf16 v3, v80, v120, v3
    v_dot2_f32_bf16 v4, v81, v121, v4
    v_dot2_f32_bf16 v3, v82, v122, v3
    v_dot2_f32_bf16 v4, v83, v123, v4
    s_waitcnt vmcnt(6)
    v_dot2_f32_bf16 v3, v84, v124, v3
    v_dot2_f32_bf16 v4, v85, v125, v4
    v_dot2_f32_bf16 v3, v86, v126, v3
    v_dot2_f32_bf16 v4, v87, v127, v4
    s_waitcnt vmcnt(5)
    v_dot2_f32_bf16 v3, v88, v128, v3
    v_dot2_f32_bf16 v4, v89, v129, v4
    v_dot2_f32_bf16 v3, v90, v130, v3
    v_dot2_f32_bf16 v4, v91, v131, v4
    s_waitcnt vmcnt(4)
    v_dot2_f32_bf16 v3, v92, v132, v3
    v_dot2_f32_bf16 v4, v93, v133, v4
    v_dot2_f32_bf16 v3, v94, v134, v3
    v_dot2_f32_bf16 v4, v95, v135, v4
    s_waitcnt vmcnt(3)
    v_dot2_f32_bf16 v3, v96, v136, v3
    v_dot2_f32_bf16 v4, v97, v137, v4
    v_dot2_f32_bf16 v3, v98, v138, v3
    v_dot2_f32_bf16 v4, v99, v139, v4
    s_waitcnt vmcnt(2)
    v_dot2_f32_bf16 v3, v100, v140, v3
    v_dot2_f32_bf16 v4, v101, v141, v4
    v_dot2_f32_bf16 v3, v102, v142, v3
    v_dot2_f32_bf16 v4, v103, v143, v4
    s_waitcnt vmcnt(1)
    v_dot2_f32_bf16 v3, v104, v144, v3
    v_dot2_f32_bf16 v4, v105, v145, v4
    v_dot2_f32_bf16 v3, v106, v146, v3
    v_dot2_f32_bf16 v4, v107, v147, v4
    s_waitcnt vmcnt(0)
    v_dot2_f32_bf16 v3, v108, v148, v3
    v_dot2_f32_bf16 v4, v109, v149, v4
    v_dot2_f32_bf16 v3, v110, v150, v3
    v_dot2_f32_bf16 v4, v111, v151, v4
    s_nop 2
    v_add_f32 v3, v3, v4
    s_nop 1
    v_add_f32_dpp v3, v3, v3 row_shr:1 row_mask:0xf bank_mask:0xf bound_ctrl:0
    s_nop 1
    v_add_f32_dpp v3, v3, v3 row_shr:2 row_mask:0xf bank_mask:0xf bound_ctrl:0
    s_nop 1
    v_add_f32_dpp v3, v3, v3 row_shr:4 row_mask:0xf bank_mask:0xf bound_ctrl:0
    v_cvt_pk_bf16_f32 v3, v3, v3
    v_and_b32 v3, 0xffff0000, v3
    v_mul_f32 v3, 0xbfb8aa3b, v3
    v_exp_f32 v3, v3
    s_nop 0
    v_add_f32 v3, 1.0, v3
    v_rcp_f32 v3, v3
    s_nop 1
    v_mov_b32_dpp v6, v3 row_shr:8 row_mask:0xf bank_mask:0xf bound_ctrl:0
    v_cvt_pk_bf16_f32 v6, v6, v3
    s_mov_b32 exec_lo, s48
    s_mov_b32 exec_hi, s48
    global_store_dwordx2 v8, v[6:7], s[42:43] sc1
    s_mov_b64 exec, -1
    s_mov_b32 s75, 262144
    s_cmp_eq_u32 s3, 0
    s_cbranch_scc0 L_fin
    s_lshl_b32 s51, s2, 7
    s_add_u32 s51, s51, 16384
    v_mov_b32 v5, s51
    v_mov_b32 v6, s55
    s_mov_b64 exec, 1
    global_store_dword v5, v6, s[42:43] sc1
    s_mov_b64 exec, -1
    s_cmp_eq_u32 s2, 0
    s_cbranch_scc0 L_fin
    v_lshlrev_b32 v5, 9, v0
    v_add_u32 v5, 16384, v5
L_keep:
    s_sub_u32 s75, s75, 1
    s_cbranch_scc1 L_end
    s_sleep 24
    global_load_dword v8, v5, s[42:43] offset:0 sc1
    global_load_dword v9, v5, s[42:43] offset:128 sc1
    global_load_dword v10, v5, s[42:43] offset:256 sc1
    global_load_dword v11, v5, s[42:43] offset:384 sc1
    s_waitcnt vmcnt(3)
    v_xor_b32 v6, s55, v8
    s_waitcnt vmcnt(2)
    v_bitop3_b32 v6, v6, s55, v9 bitop3:0xf6
    s_waitcnt vmcnt(1)
    v_bitop3_b32 v6, v6, s55, v10 bitop3:0xf6
    s_waitcnt vmcnt(0)
    v_bitop3_b32 v6, v6, s55, v11 bitop3:0xf6
    v_cmp_ne_u32 vcc, 0, v6
    s_cbranch_vccnz L_keep
    v_mov_b32 v5, 8448
    v_mov_b32 v6, s55
    s_mov_b64 exec, 1
    global_store_dword v5, v6, s[42:43]
    s_mov_b64 exec, -1
    s_branch L_fin
L_hook:
    s_cmp_eq_u32 s53, 2
    s_cbranch_scc0 L_hook2
    v_add_u32 v46, 163840, v46
    global_load_dwordx2 v[176:177], v46, s[4:5]
    global_load_dwordx2 v[178:179], v46, s[4:5] offset:1280
    v_add_u32 v46, 163840, v46
    global_load_dwordx2 v[180:181], v46, s[4:5]
    global_load_dwordx2 v[182:183], v46, s[4:5] offset:1280
    s_branch L_hookback
L_hook2:
    v_add_u32 v46, 163840, v46
    global_load_dwordx2 v[192:193], v46, s[4:5]
    global_load_dwordx2 v[194:195], v46, s[4:5] offset:1280
    s_branch L_hookback
L_far:
    s_lshr_b32 s48, s3, 2
    s_mul_i32 s49, s48, 4608
    s_add_u32 s49, s49, 464
    v_add_u32_sdwa v192, v245, s49 dst_sel:DWORD dst_unused:UNUSED_PAD src0_sel:WORD_0 src1_sel:DWORD
    s_mov_b32 s49, 9680
    v_add_u32_sdwa v193, v245, s49 dst_sel:DWORD dst_unused:UNUSED_PAD src0_sel:WORD_0 src1_sel:DWORD
    s_mul_i32 s49, s48, 15872
    s_add_u32 s49, s49, 91904
    v_add_u32_sdwa v194, v244, s49 dst_sel:DWORD dst_unused:UNUSED_PAD src0_sel:WORD_1 src1_sel:DWORD
    s_mul_i32 s49, s48, 7936
    s_add_u32 s49, s49, 123648
    v_add_u32_sdwa v195, v244, s49 dst_sel:DWORD dst_unused:UNUSED_PAD src0_sel:WORD_1 src1_sel:DWORD
    s_mul_i32 s49, s48, 3072
    s_mov_b32 m0, s49
    s_lshl_b32 s49, s48, 2
    s_add_u32 s49, s49, 78336
    v_mov_b32 v197, s49
    v_mov_b32 v198, 2
    ds_write_b32 v197, v198
    s_cmp_eq_u32 s3, 99
    s_waitcnt lgkmcnt(0)
    s_barrier
    s_setprio 3
L_fb1:
    ds_read_b128 v[152:155], v192 offset:16
    ds_read_b128 v[156:159], v192 offset:0
    ds_read_b128 v[160:163], v193 offset:16
    ds_read_b128 v[164:167], v193 offset:0
    s_waitcnt lgkmcnt(3)
    v_mfma_f32_16x16x32_bf16 v[120:123], v[152:155], v[248:251], 0
    s_waitcnt lgkmcnt(2)
    v_mfma_f32_16x16x32_bf16 v[124:127], v[156:159], v[248:251], 0
    s_waitcnt lgkmcnt(1)
    v_mfma_f32_16x16x32_bf16 v[136:139], v[160:163], v[248:251], 0
    s_waitcnt lgkmcnt(0)
    v_mfma_f32_16x16x32_bf16 v[140:143], v[164:167], v[248:251], 0
    v_mfma_f32_16x16x32_bf16 v[128:131], v[152:155], v[252:255], 0
    v_mfma_f32_16x16x32_bf16 v[132:135], v[156:159], v[252:255], 0
    s_nop 1
    v_cvt_pk_bf16_f32 v72, v124, v120
    v_cvt_pk_bf16_f32 v73, v125, v121
    v_mfma_f32_16x16x32_bf16 v[144:147], v[160:163], v[252:255], 0
    v_cvt_pk_bf16_f32 v74, v126, v122
    v_cvt_pk_bf16_f32 v75, v127, v123
    v_mfma_f32_16x16x32_bf16 v[148:151], v[164:167], v[252:255], 0
    ds_read_b128 v[152:155], v192 offset:528
    ds_read_b128 v[156:159], v192 offset:512
    ds_read_b128 v[160:163], v193 offset:528
    ds_read_b128 v[164:167], v193 offset:512
    v_cvt_pk_bf16_f32 v96, v140, v136
    v_cvt_pk_bf16_f32 v97, v141, v137
    v_cvt_pk_bf16_f32 v98, v142, v138
    v_cvt_pk_bf16_f32 v99, v143, v139
    v_cvt_pk_bf16_f32 v76, v132, v128
    v_cvt_pk_bf16_f32 v77, v133, v129
    v_cvt_pk_bf16_f32 v78, v134, v130
    v_cvt_pk_bf16_f32 v79, v135, v131
    v_cvt_pk_bf16_f32 v100, v148, v144
    v_cvt_pk_bf16_f32 v101, v149, v145
    v_cvt_pk_bf16_f32 v102, v150, v146
    v_cvt_pk_bf16_f32 v103, v151, v147
    s_waitcnt lgkmcnt(3)
    v_mfma_f32_16x16x32_bf16 v[120:123], v[152:155], v[248:251], 0
    s_waitcnt lgkmcnt(2)
    v_mfma_f32_16x16x32_bf16 v[124:127], v[156:159], v[248:251], 0
    s_waitcnt lgkmcnt(1)
    v_mfma_f32_16x16x32_bf16 v[136:139], v[160:163], v[248:251], 0
    s_waitcnt lgkmcnt(0)
    v_mfma_f32_16x16x32_bf16 v[140:143], v[164:167], v[248:251], 0
    v_mfma_f32_16x16x32_bf16 v[128:131], v[152:155], v[252:255], 0
    v_mfma_f32_16x16x32_bf16 v[132:135], v[156:159], v[252:255], 0
    s_nop 1
    v_cvt_pk_bf16_f32 v80, v124, v120
    v_cvt_pk_bf16_f32 v81, v125, v121
    v_mfma_f32_16x16x32_bf16 v[144:147], v[160:163], v[252:255], 0
    v_cvt_pk_bf16_f32 v82, v126, v122
    v_cvt_pk_bf16_f32 v83, v127, v123
    v_mfma_f32_16x16x32_bf16 v[148:151], v[164:167], v[252:255], 0
    ds_read_b128 v[152:155], v192 offset:1040
    ds_read_b128 v[156:159], v192 offset:1024
    ds_read_b128 v[160:163], v193 offset:1040
    ds_read_b128 v[164:167], v193 offset:1024
    v_cvt_pk_bf16_f32 v104, v140, v136
    v_cvt_pk_bf16_f32 v105, v141, v137
    v_cvt_pk_bf16_f32 v106, v142, v138
    v_cvt_pk_bf16_f32 v107, v143, v139
    v_cvt_pk_bf16_f32 v84, v132, v128
    v_cvt_pk_bf16_f32 v85, v133, v129
    v_cvt_pk_bf16_f32 v86, v134, v130
    v_cvt_pk_bf16_f32 v87, v135, v131
    v_cvt_pk_bf16_f32 v108, v148, v144
    v_cvt_pk_bf16_f32 v109, v149, v145
    v_cvt_pk_bf16_f32 v110, v150, v146
    v_cvt_pk_bf16_f32 v111, v151, v147
    s_cmp_eq_u32 s3, 7
    s_cbranch_scc1 L_fb2
    s_setprio 2
L_fb2:
    s_waitcnt lgkmcnt(0)
    ds_read_b128 v[0:3], v194 offset:1276
    ds_read_b128 v[24:27], v194 offset:9212
    ds_read_b128 v[48:51], v195 offset:1276
    ds_read_b128 v[4:7], v194 offset:1468
    ds_read_b128 v[28:31], v194 offset:9404
    ds_read_b128 v[52:55], v195 offset:1468
    s_waitcnt lgkmcnt(5)
    v_mfma_f32_16x16x32_bf16 v[168:171], v[0:3], v[72:75], 0
    s_waitcnt lgkmcnt(4)
    ds_read_b128 v[8:11], v194 offset:1212
    ds_read_b128 v[32:35], v194 offset:9148
    v_mfma_f32_16x16x32_bf16 v[172:175], v[24:27], v[72:75], 0
    s_waitcnt lgkmcnt(5)
    ds_read_b128 v[56:59], v195 offset:1212
    ds_read_b128 v[12:15], v194 offset:1404
    v_mfma_f32_16x16x32_bf16 v[176:179], v[48:51], v[96:99], 0
    s_waitcnt lgkmcnt(6)
    ds_read_b128 v[36:39], v194 offset:9340
    ds_read_b128 v[60:63], v195 offset:1404
    v_mfma_f32_16x16x32_bf16 v[168:171], v[4:7], v[76:79], v[168:171]
    s_waitcnt lgkmcnt(7)
    v_mfma_f32_16x16x32_bf16 v[172:175], v[28:31], v[76:79], v[172:175]
    s_waitcnt lgkmcnt(6)
    v_mfma_f32_16x16x32_bf16 v[176:179], v[52:55], v[100:103], v[176:179]
    s_waitcnt lgkmcnt(5)
    v_mov_b32 v198, 3
    v_mfma_f32_16x16x32_bf16 v[180:183], v[8:11], v[72:75], 0
    s_waitcnt lgkmcnt(4)
    ds_read_b128 v[16:19], v194 offset:1148
    ds_read_b128 v[40:43], v194 offset:9084
    v_mfma_f32_16x16x32_bf16 v[184:187], v[32:35], v[72:75], 0
    s_waitcnt lgkmcnt(5)
    ds_read_b128 v[64:67], v195 offset:1148
    ds_read_b128 v[20:23], v194 offset:1340
    v_mfma_f32_16x16x32_bf16 v[188:191], v[56:59], v[96:99], 0
    s_waitcnt lgkmcnt(6)
    ds_read_b128 v[44:47], v194 offset:9276
    ds_read_b128 v[68:71], v195 offset:1340
    v_mfma_f32_16x16x32_bf16 v[180:183], v[12:15], v[76:79], v[180:183]
    s_waitcnt lgkmcnt(7)
    ds_write_addtid_b32 v168 offset:13824
    ds_write_addtid_b32 v169 offset:14080
    v_mfma_f32_16x16x32_bf16 v[184:187], v[36:39], v[76:79], v[184:187]
    s_waitcnt lgkmcnt(8)
    ds_write_addtid_b32 v170 offset:14336
    ds_write_addtid_b32 v171 offset:14592
    v_mfma_f32_16x16x32_bf16 v[188:191], v[60:63], v[100:103], v[188:191]
    ds_write_addtid_b32 v172 offset:14848
    ds_write_addtid_b32 v173 offset:15104
    v_mfma_f32_16x16x32_bf16 v[180:183], v[0:3], v[80:83], v[180:183]
    ds_write_addtid_b32 v174 offset:15360
    ds_write_addtid_b32 v175 offset:15616
    v_mfma_f32_16x16x32_bf16 v[184:187], v[24:27], v[80:83], v[184:187]
    ds_write_addtid_b32 v176 offset:15872
    ds_write_addtid_b32 v177 offset:16128
    v_mfma_f32_16x16x32_bf16 v[188:191], v[48:51], v[104:107], v[188:191]
    ds_write_addtid_b32 v178 offset:16384
    ds_write_addtid_b32 v179 offset:16640
    v_mfma_f32_16x16x32_bf16 v[180:183], v[4:7], v[84:87], v[180:183]
    ds_write_b32 v197, v198
    v_mfma_f32_16x16x32_bf16 v[184:187], v[28:31], v[84:87], v[184:187]
    s_setprio 2
    v_mfma_f32_16x16x32_bf16 v[188:191], v[52:55], v[108:111], v[188:191]
    v_mov_b32 v198, 4
    v_mfma_f32_16x16x32_bf16 v[120:123], v[152:155], v[248:251], 0
    v_mfma_f32_16x16x32_bf16 v[124:127], v[156:159], v[248:251], 0
    s_nop 0
    ds_write_addtid_b32 v180 offset:19968
    ds_write_addtid_b32 v181 offset:20224
    v_mfma_f32_16x16x32_bf16 v[136:139], v[160:163], v[248:251], 0
    ds_write_addtid_b32 v182 offset:20480
    ds_write_addtid_b32 v183 offset:20736
    v_mfma_f32_16x16x32_bf16 v[140:143], v[164:167], v[248:251], 0
    ds_write_addtid_b32 v184 offset:20992
    ds_write_addtid_b32 v185 offset:21248
    v_mfma_f32_16x16x32_bf16 v[128:131], v[152:155], v[252:255], 0
    ds_write_addtid_b32 v186 offset:21504
    ds_write_addtid_b32 v187 offset:21760
    v_mfma_f32_16x16x32_bf16 v[132:135], v[156:159], v[252:255], 0
    ds_write_addtid_b32 v188 offset:22016
    ds_write_addtid_b32 v189 offset:22272
    v_mfma_f32_16x16x32_bf16 v[144:147], v[160:163], v[252:255], 0
    ds_write_addtid_b32 v190 offset:22528
    ds_write_addtid_b32 v191 offset:22784
    v_mfma_f32_16x16x32_bf16 v[148:151], v[164:167], v[252:255], 0
    s_waitcnt lgkmcnt(14)
    ds_write_b32 v197, v198
    v_mfma_f32_16x16x32_bf16 v[168:171], v[16:19], v[72:75], 0
    s_cbranch_scc1 L_pr2
    s_setprio 1
L_pr2:
    v_cvt_pk_bf16_f32 v88, v124, v120
    v_cvt_pk_bf16_f32 v89, v125, v121
    v_mfma_f32_16x16x32_bf16 v[172:175], v[40:43], v[72:75], 0
    v_cvt_pk_bf16_f32 v90, v126, v122
    v_cvt_pk_bf16_f32 v91, v127, v123
    v_mfma_f32_16x16x32_bf16 v[176:179], v[64:67], v[96:99], 0
    v_cvt_pk_bf16_f32 v112, v140, v136
    v_cvt_pk_bf16_f32 v113, v141, v137
    v_mfma_f32_16x16x32_bf16 v[168:171], v[20:23], v[76:79], v[168:171]
    v_cvt_pk_bf16_f32 v114, v142, v138
    v_cvt_pk_bf16_f32 v115, v143, v139
    v_mfma_f32_16x16x32_bf16 v[172:175], v[44:47], v[76:79], v[172:175]
    v_cvt_pk_bf16_f32 v92, v132, v128
    v_cvt_pk_bf16_f32 v93, v133, v129
    v_mfma_f32_16x16x32_bf16 v[176:179], v[68:71], v[100:103], v[176:179]
    v_cvt_pk_bf16_f32 v94, v134, v130
    v_cvt_pk_bf16_f32 v95, v135, v131
    v_mfma_f32_16x16x32_bf16 v[168:171], v[8:11], v[80:83], v[168:171]
    v_cvt_pk_bf16_f32 v116, v148, v144
    v_cvt_pk_bf16_f32 v117, v149, v145
    v_mfma_f32_16x16x32_bf16 v[172:175], v[32:35], v[80:83], v[172:175]
    v_cvt_pk_bf16_f32 v118, v150, v146
    v_cvt_pk_bf16_f32 v119, v151, v147
    v_mfma_f32_16x16x32_bf16 v[176:179], v[56:59], v[104:107], v[176:179]
    ds_read_b128 v[152:155], v192 offset:1552
    ds_read_b128 v[156:159], v192 offset:1536
    v_mfma_f32_16x16x32_bf16 v[168:171], v[12:15], v[84:87], v[168:171]
    ds_read_b128 v[160:163], v193 offset:1552
    ds_read_b128 v[164:167], v193 offset:1536
    v_mfma_f32_16x16x32_bf16 v[172:175], v[36:39], v[84:87], v[172:175]
    v_mfma_f32_16x16x32_bf16 v[176:179], v[60:63], v[108:111], v[176:179]
    v_mfma_f32_16x16x32_bf16 v[168:171], v[0:3], v[88:91], v[168:171]
    v_mfma_f32_16x16x32_bf16 v[172:175], v[24:27], v[88:91], v[172:175]
    v_mfma_f32_16x16x32_bf16 v[176:179], v[48:51], v[112:115], v[176:179]
    v_mfma_f32_16x16x32_bf16 v[168:171], v[4:7], v[92:95], v[168:171]
    v_mfma_f32_16x16x32_bf16 v[172:175], v[28:31], v[92:95], v[172:175]
    v_mfma_f32_16x16x32_bf16 v[176:179], v[52:55], v[116:119], v[176:179]
    s_waitcnt lgkmcnt(3)
    v_mov_b32 v198, 5
    v_mfma_f32_16x16x32_bf16 v[120:123], v[152:155], v[248:251], 0
    s_waitcnt lgkmcnt(2)
    v_mfma_f32_16x16x32_bf16 v[124:127], v[156:159], v[248:251], 0
    s_waitcnt lgkmcnt(1)
    ds_write_addtid_b32 v168 offset:26112
    ds_write_addtid_b32 v169 offset:26368
    v_mfma_f32_16x16x32_bf16 v[136:139], v[160:163], v[248:251], 0
    s_waitcnt lgkmcnt(2)
    ds_write_addtid_b32 v170 offset:26624
    ds_write_addtid_b32 v171 offset:26880
    v_mfma_f32_16x16x32_bf16 v[140:143], v[164:167], v[248:251], 0
    ds_write_addtid_b32 v172 offset:27136
    ds_write_addtid_b32 v173 offset:27392
    v_mfma_f32_16x16x32_bf16 v[128:131], v[152:155], v[252:255], 0
    ds_write_addtid_b32 v174 offset:27648
    ds_write_addtid_b32 v175 offset:27904
    v_mfma_f32_16x16x32_bf16 v[132:135], v[156:159], v[252:255], 0
    ds_write_addtid_b32 v176 offset:28160
    ds_write_addtid_b32 v177 offset:28416
    v_mfma_f32_16x16x32_bf16 v[144:147], v[160:163], v[252:255], 0
    ds_write_addtid_b32 v178 offset:28672
    ds_write_addtid_b32 v179 offset:28928
    v_mfma_f32_16x16x32_bf16 v[148:151], v[164:167], v[252:255], 0
    ds_write_b32 v197, v198
    v_mfma_f32_16x16x32_bf16 v[180:183], v[16:19], v[80:83], 0
    s_setprio 1
    v_cvt_pk_bf16_f32 v72, v124, v120
    v_cvt_pk_bf16_f32 v73, v125, v121
    v_mfma_f32_16x16x32_bf16 v[184:187], v[40:43], v[80:83], 0
    v_cvt_pk_bf16_f32 v74, v126, v122
    v_cvt_pk_bf16_f32 v75, v127, v123
    v_mfma_f32_16x16x32_bf16 v[188:191], v[64:67], v[104:107], 0
    v_cvt_pk_bf16_f32 v96, v140, v136
    v_cvt_pk_bf16_f32 v97, v141, v137
    v_mfma_f32_16x16x32_bf16 v[180:183], v[20:23], v[84:87], v[180:183]
    v_cvt_pk_bf16_f32 v98, v142, v138
    v_cvt_pk_bf16_f32 v99, v143, v139
    v_mfma_f32_16x16x32_bf16 v[184:187], v[44:47], v[84:87], v[184:187]
    v_cvt_pk_bf16_f32 v76, v132, v128
    v_cvt_pk_bf16_f32 v77, v133, v129
    v_mfma_f32_16x16x32_bf16 v[188:191], v[68:71], v[108:111], v[188:191]
    v_cvt_pk_bf16_f32 v78, v134, v130
    v_cvt_pk_bf16_f32 v79, v135, v131
    v_mfma_f32_16x16x32_bf16 v[180:183], v[8:11], v[88:91], v[180:183]
    v_cvt_pk_bf16_f32 v100, v148, v144
    v_cvt_pk_bf16_f32 v101, v149, v145
    v_mfma_f32_16x16x32_bf16 v[184:187], v[32:35], v[88:91], v[184:187]
    v_cvt_pk_bf16_f32 v102, v150, v146
    v_cvt_pk_bf16_f32 v103, v151, v147
    v_mfma_f32_16x16x32_bf16 v[188:191], v[56:59], v[112:115], v[188:191]
    ds_read_b128 v[152:155], v192 offset:2064
    ds_read_b128 v[156:159], v192 offset:2048
    v_mfma_f32_16x16x32_bf16 v[180:183], v[12:15], v[92:95], v[180:183]
    ds_read_b128 v[160:163], v193 offset:2064
    ds_read_b128 v[164:167], v193 offset:2048
    v_mfma_f32_16x16x32_bf16 v[184:187], v[36:39], v[92:95], v[184:187]
    v_mfma_f32_16x16x32_bf16 v[188:191], v[60:63], v[116:119], v[188:191]
    v_mfma_f32_16x16x32_bf16 v[180:183], v[0:3], v[72:75], v[180:183]
    v_mfma_f32_16x16x32_bf16 v[184:187], v[24:27], v[72:75], v[184:187]
    v_mfma_f32_16x16x32_bf16 v[188:191], v[48:51], v[96:99], v[188:191]
    v_mfma_f32_16x16x32_bf16 v[180:183], v[4:7], v[76:79], v[180:183]
    v_mfma_f32_16x16x32_bf16 v[184:187], v[28:31], v[76:79], v[184:187]
    v_mfma_f32_16x16x32_bf16 v[188:191], v[52:55], v[100:103], v[188:191]
    s_waitcnt lgkmcnt(3)
    v_mov_b32 v198, 6
    v_mfma_f32_16x16x32_bf16 v[120:123], v[152:155], v[248:251], 0
    s_waitcnt lgkmcnt(2)
    v_mfma_f32_16x16x32_bf16 v[124:127], v[156:159], v[248:251], 0
    s_waitcnt lgkmcnt(1)
    ds_write_addtid_b32 v180 offset:32256
    ds_write_addtid_b32 v181 offset:32512
    v_mfma_f32_16x16x32_bf16 v[136:139], v[160:163], v[248:251], 0
    s_waitcnt lgkmcnt(2)
    ds_write_addtid_b32 v182 offset:32768
    ds_write_addtid_b32 v183 offset:33024
    v_mfma_f32_16x16x32_bf16 v[140:143], v[164:167], v[248:251], 0
    ds_write_addtid_b32 v184 offset:33280
    ds_write_addtid_b32 v185 offset:33536
    v_mfma_f32_16x16x32_bf16 v[128:131], v[152:155], v[252:255], 0
    ds_write_addtid_b32 v186 offset:33792
    ds_write_addtid_b32 v187 offset:34048
    v_mfma_f32_16x16x32_bf16 v[132:135], v[156:159], v[252:255], 0
    ds_write_addtid_b32 v188 offset:34304
    ds_write_addtid_b32 v189 offset:34560
    v_mfma_f32_16x16x32_bf16 v[144:147], v[160:163], v[252:255], 0
    ds_write_addtid_b32 v190 offset:34816
    ds_write_addtid_b32 v191 offset:35072
    v_mfma_f32_16x16x32_bf16 v[148:151], v[164:167], v[252:255], 0
    ds_write_b32 v197, v198
    v_mfma_f32_16x16x32_bf16 v[168:171], v[16:19], v[88:91], 0
    s_cbranch_scc1 L_pr4
    s_setprio 0
L_pr4:
    v_cvt_pk_bf16_f32 v80, v124, v120
    v_cvt_pk_bf16_f32 v81, v125, v121
    v_mfma_f32_16x16x32_bf16 v[172:175], v[40:43], v[88:91], 0
    v_cvt_pk_bf16_f32 v82, v126, v122
    v_cvt_pk_bf16_f32 v83, v127, v123
    v_mfma_f32_16x16x32_bf16 v[176:179], v[64:67], v[112:115], 0
    v_cvt_pk_bf16_f32 v104, v140, v136
    v_cvt_pk_bf16_f32 v105, v141, v137
    v_mfma_f32_16x16x32_bf16 v[168:171], v[20:23], v[92:95], v[168:171]
    v_cvt_pk_bf16_f32 v106, v142, v138
    v_cvt_pk_bf16_f32 v107, v143, v139
    v_mfma_f32_16x16x32_bf16 v[172:175], v[44:47], v[92:95], v[172:175]
    v_cvt_pk_bf16_f32 v84, v132, v128
    v_cvt_pk_bf16_f32 v85, v133, v129
    v_mfma_f32_16x16x32_bf16 v[176:179], v[68:71], v[116:119], v[176:179]
    v_cvt_pk_bf16_f32 v86, v134, v130
    v_cvt_pk_bf16_f32 v87, v135, v131
    v_mfma_f32_16x16x32_bf16 v[168:171], v[8:11], v[72:75], v[168:171]
    v_cvt_pk_bf16_f32 v108, v148, v144
    v_cvt_pk_bf16_f32 v109, v149, v145
    v_mfma_f32_16x16x32_bf16 v[172:175], v[32:35], v[72:75], v[172:175]
    v_cvt_pk_bf16_f32 v110, v150, v146
    v_cvt_pk_bf16_f32 v111, v151, v147
    v_mfma_f32_16x16x32_bf16 v[176:179], v[56:59], v[96:99], v[176:179]
    ds_read_b128 v[152:155], v192 offset:2576
    ds_read_b128 v[156:159], v192 offset:2560
    v_mfma_f32_16x16x32_bf16 v[168:171], v[12:15], v[76:79], v[168:171]
    ds_read_b128 v[160:163], v193 offset:2576
    ds_read_b128 v[164:167], v193 offset:2560
    v_mfma_f32_16x16x32_bf16 v[172:175], v[36:39], v[76:79], v[172:175]
    v_mfma_f32_16x16x32_bf16 v[176:179], v[60:63], v[100:103], v[176:179]
    v_mfma_f32_16x16x32_bf16 v[168:171], v[0:3], v[80:83], v[168:171]
    v_mfma_f32_16x16x32_bf16 v[172:175], v[24:27], v[80:83], v[172:175]
    v_mfma_f32_16x16x32_bf16 v[176:179], v[48:51], v[104:107], v[176:179]
    v_mfma_f32_16x16x32_bf16 v[168:171], v[4:7], v[84:87], v[168:171]
    v_mfma_f32_16x16x32_bf16 v[172:175], v[28:31], v[84:87], v[172:175]
    v_mfma_f32_16x16x32_bf16 v[176:179], v[52:55], v[108:111], v[176:179]
    s_waitcnt lgkmcnt(3)
    v_mov_b32 v198, 7
    v_mfma_f32_16x16x32_bf16 v[120:123], v[152:155], v[248:251], 0
    s_waitcnt lgkmcnt(2)
    v_mfma_f32_16x16x32_bf16 v[124:127], v[156:159], v[248:251], 0
    s_waitcnt lgkmcnt(1)
    ds_write_addtid_b32 v168 offset:38400
    ds_write_addtid_b32 v169 offset:38656
    v_mfma_f32_16x16x32_bf16 v[136:139], v[160:163], v[248:251], 0
    s_waitcnt lgkmcnt(2)
    ds_write_addtid_b32 v170 offset:38912
    ds_write_addtid_b32 v171 offset:39168
    v_mfma_f32_16x16x32_bf16 v[140:143], v[164:167], v[248:251], 0
    ds_write_addtid_b32 v172 offset:39424
    ds_write_addtid_b32 v173 offset:39680
    v_mfma_f32_16x16x32_bf16 v[128:131], v[152:155], v[252:255], 0
    ds_write_addtid_b32 v174 offset:39936
    ds_write_addtid_b32 v175 offset:40192
    v_mfma_f32_16x16x32_bf16 v[132:135], v[156:159], v[252:255], 0
    ds_write_addtid_b32 v176 offset:40448
    ds_write_addtid_b32 v177 offset:40704
    v_mfma_f32_16x16x32_bf16 v[144:147], v[160:163], v[252:255], 0
    ds_write_addtid_b32 v178 offset:40960
    ds_write_addtid_b32 v179 offset:41216
    v_mfma_f32_16x16x32_bf16 v[148:151], v[164:167], v[252:255], 0
    ds_write_b32 v197, v198
    v_mfma_f32_16x16x32_bf16 v[180:183], v[16:19], v[72:75], 0
    s_setprio 0
    v_cvt_pk_bf16_f32 v88, v124, v120
    v_cvt_pk_bf16_f32 v89, v125, v121
    v_mfma_f32_16x16x32_bf16 v[184:187], v[40:43], v[72:75], 0
    v_cvt_pk_bf16_f32 v90, v126, v122
    v_cvt_pk_bf16_f32 v91, v127, v123
    v_mfma_f32_16x16x32_bf16 v[188:191], v[64:67], v[96:99], 0
    v_cvt_pk_bf16_f32 v112, v140, v136
    v_cvt_pk_bf16_f32 v113, v141, v137
    v_mfma_f32_16x16x32_bf16 v[180:183], v[20:23], v[76:79], v[180:183]
    v_cvt_pk_bf16_f32 v114, v142, v138
    v_cvt_pk_bf16_f32 v115, v143, v139
    v_mfma_f32_16x16x32_bf16 v[184:187], v[44:47], v[76:79], v[184:187]
    v_cvt_pk_bf16_f32 v92, v132, v128
    v_cvt_pk_bf16_f32 v93, v133, v129
    v_mfma_f32_16x16x32_bf16 v[188:191], v[68:71], v[100:103], v[188:191]
    v_cvt_pk_bf16_f32 v94, v134, v130
    v_cvt_pk_bf16_f32 v95, v135, v131
    v_mfma_f32_16x16x32_bf16 v[180:183], v[8:11], v[80:83], v[180:183]
    v_cvt_pk_bf16_f32 v116, v148, v144
    v_cvt_pk_bf16_f32 v117, v149, v145
    v_mfma_f32_16x16x32_bf16 v[184:187], v[32:35], v[80:83], v[184:187]
    v_cvt_pk_bf16_f32 v118, v150, v146
    v_cvt_pk_bf16_f32 v119, v151, v147
    v_mfma_f32_16x16x32_bf16 v[188:191], v[56:59], v[104:107], v[188:191]
    v_mfma_f32_16x16x32_bf16 v[180:183], v[12:15], v[84:87], v[180:183]
    v_mfma_f32_16x16x32_bf16 v[184:187], v[36:39], v[84:87], v[184:187]
    v_mfma_f32_16x16x32_bf16 v[188:191], v[60:63], v[108:111], v[188:191]
    v_mfma_f32_16x16x32_bf16 v[180:183], v[0:3], v[88:91], v[180:183]
    v_mfma_f32_16x16x32_bf16 v[184:187], v[24:27], v[88:91], v[184:187]
    v_mfma_f32_16x16x32_bf16 v[188:191], v[48:51], v[112:115], v[188:191]
    v_mfma_f32_16x16x32_bf16 v[180:183], v[4:7], v[92:95], v[180:183]
    v_mfma_f32_16x16x32_bf16 v[184:187], v[28:31], v[92:95], v[184:187]
    v_mfma_f32_16x16x32_bf16 v[188:191], v[52:55], v[116:119], v[188:191]
    v_mov_b32 v198, 8
    s_nop 4
    ds_write_addtid_b32 v180 offset:44544
    ds_write_addtid_b32 v181 offset:44800
    ds_write_addtid_b32 v182 offset:45056
    ds_write_addtid_b32 v183 offset:45312
    ds_write_addtid_b32 v184 offset:45568
    ds_write_addtid_b32 v185 offset:45824
    ds_write_addtid_b32 v186 offset:46080
    ds_write_addtid_b32 v187 offset:46336
    ds_write_addtid_b32 v188 offset:46592
    ds_write_addtid_b32 v189 offset:46848
    ds_write_addtid_b32 v190 offset:47104
    ds_write_addtid_b32 v191 offset:47360
    ds_write_b32 v197, v198
    s_branch L_fin
L_main:
    s_mul_i32 s48, s3, 15872
    s_add_u32 s49, s48, 91904
    v_add_u32_sdwa v246, v244, s49 dst_sel:DWORD dst_unused:UNUSED_PAD src0_sel:WORD_0 src1_sel:DWORD
    v_add_u32_sdwa v247, v244, s49 dst_sel:DWORD dst_unused:UNUSED_PAD src0_sel:WORD_1 src1_sel:DWORD
    s_mov_b32 s49, 78336
    v_add_u32_sdwa v238, v245, s49 dst_sel:DWORD dst_unused:UNUSED_PAD src0_sel:WORD_1 src1_sel:DWORD
    s_mul_i32 s49, s3, 4608
    v_add_u32_sdwa v245, v245, s49 dst_sel:DWORD dst_unused:UNUSED_PAD src0_sel:WORD_0 src1_sel:DWORD
    s_lshl_b32 s49, s3, 2
    s_lshr_b32 s50, 0x230, s49
    s_and_b32 s50, s50, 15
    s_lshl_b32 s50, s50, 10
    s_add_u32 s50, s50, 13824
    v_lshl_add_u32 v236, v0, 2, s50
    s_cmp_eq_u32 s3, 2
    s_cselect_b32 s50, 3, 1
    s_lshl_b32 s50, s50, 10
    v_add_u32 v243, s50, v236
    v_add_u32 v237, 139520, v47
    s_mul_i32 s49, s3, 4384
    s_add_u32 s49, s49, 32768
    s_mov_b32 m0, s49
    v_mov_b32 v242, 0
    ds_write_addtid_b32 v242 offset:49920
    s_setprio 2
    ds_read_b64 v[0:1], v246 offset:1088
    ds_read_b64 v[2:3], v246 offset:1096
    ds_read_b64 v[4:5], v246 offset:1024
    ds_read_b64 v[6:7], v246 offset:1032
    ds_read_b64 v[8:9], v246 offset:960
    ds_read_b64 v[10:11], v246 offset:968
    ds_read_b64 v[12:13], v246 offset:896
    ds_read_b64 v[14:15], v246 offset:904
    ds_read_b64 v[16:17], v246 offset:832
    ds_read_b64 v[18:19], v246 offset:840
    ds_read_b64 v[20:21], v246 offset:768
    ds_read_b64 v[22:23], v246 offset:776
    ds_read_b64 v[24:25], v246 offset:704
    ds_read_b64 v[26:27], v246 offset:712
    ds_read_b64 v[28:29], v246 offset:640
    ds_read_b64 v[30:31], v246 offset:648
    ds_read_b64 v[32:33], v246 offset:576
    ds_read_b64 v[34:35], v246 offset:584
    ds_read_b64 v[36:37], v246 offset:512
    ds_read_b64 v[38:39], v246 offset:520
    ds_read_b64 v[40:41], v246 offset:448
    ds_read_b64 v[42:43], v246 offset:456
    ds_read_b64 v[44:45], v246 offset:384
    ds_read_b64 v[46:47], v246 offset:392
    ds_read_b64 v[48:49], v246 offset:320
    ds_read_b64 v[50:51], v246 offset:328
    ds_read_b64 v[52:53], v246 offset:256
    ds_read_b64 v[54:55], v246 offset:264
    ds_read_b64 v[56:57], v246 offset:192
    ds_read_b64 v[58:59], v246 offset:200
    ds_read_b64 v[60:61], v246 offset:128
    ds_read_b64 v[62:63], v246 offset:136
    ds_read_b64 v[64:65], v246 offset:64
    ds_read_b64 v[66:67], v246 offset:72
    s_waitcnt lgkmcnt(0)
    s_barrier
    ds_read_b128 v[136:139], v245 offset:480
    ds_read_b128 v[140:143], v245 offset:416
    ds_read_b128 v[144:147], v245 offset:352
    ds_read_b128 v[148:151], v245 offset:288
    ds_read_b128 v[152:155], v245 offset:224
    ds_read_b128 v[156:159], v245 offset:160
    ds_read_b128 v[160:163], v245 offset:96
    ds_read_b128 v[164:167], v245 offset:32
    ds_read_b64 v[68:69], v246 offset:9024
    ds_read_b64 v[70:71], v246 offset:9032
    ds_read_b64 v[72:73], v246 offset:8960
    ds_read_b64 v[74:75], v246 offset:8968
    s_waitcnt lgkmcnt(11)
    v_mfma_f32_16x16x32_bf16 v[172:175], v[136:139], v[0:3], 0
    s_waitcnt lgkmcnt(10)
    ds_read_b64 v[76:77], v246 offset:8896
    ds_read_b64 v[78:79], v246 offset:8904
    v_mfma_f32_16x16x32_bf16 v[172:175], v[140:143], v[4:7], v[172:175]
    s_waitcnt lgkmcnt(11)
    ds_read_b64 v[80:81], v246 offset:8832
    ds_read_b64 v[82:83], v246 offset:8840
    v_mfma_f32_16x16x32_bf16 v[172:175], v[144:147], v[8:11], v[172:175]
    s_waitcnt lgkmcnt(12)
    ds_read_b64 v[84:85], v246 offset:8768
    ds_read_b64 v[86:87], v246 offset:8776
    v_mfma_f32_16x16x32_bf16 v[172:175], v[148:151], v[12:15], v[172:175]
    s_waitcnt lgkmcnt(13)
    ds_read_b64 v[88:89], v246 offset:8704
    ds_read_b64 v[90:91], v246 offset:8712
    v_mfma_f32_16x16x32_bf16 v[172:175], v[152:155], v[16:19], v[172:175]
    s_waitcnt lgkmcnt(14)
    ds_read_b64 v[92:93], v246 offset:8640
    ds_read_b64 v[94:95], v246 offset:8648
    v_mfma_f32_16x16x32_bf16 v[172:175], v[156:159], v[20:23], v[172:175]
    s_waitcnt lgkmcnt(14)
    ds_read_b64 v[96:97], v246 offset:8576
    ds_read_b64 v[98:99], v246 offset:8584
    v_mfma_f32_16x16x32_bf16 v[172:175], v[160:163], v[24:27], v[172:175]
    ds_read_b32 v239, v238
    ds_read_b128 v[196:199], v237 offset:0
    v_mfma_f32_16x16x32_bf16 v[172:175], v[164:167], v[28:31], v[172:175]
    s_waitcnt lgkmcnt(14)
    v_mfma_f32_16x16x32_bf16 v[176:179], v[136:139], v[68:71], 0
    v_mfma_f32_16x16x32_bf16 v[176:179], v[140:143], v[72:75], v[176:179]
    s_waitcnt lgkmcnt(12)
    v_mfma_f32_16x16x32_bf16 v[176:179], v[144:147], v[76:79], v[176:179]
    s_waitcnt lgkmcnt(10)
    ds_read_b128 v[224:227], v245 offset:464
    ds_read_b64 v[100:101], v246 offset:8512
    v_mfma_f32_16x16x32_bf16 v[176:179], v[148:151], v[80:83], v[176:179]
    s_waitcnt lgkmcnt(10)
    ds_read_b64 v[102:103], v246 offset:8520
    ds_read_b64 v[104:105], v246 offset:8448
    v_mfma_f32_16x16x32_bf16 v[176:179], v[152:155], v[84:87], v[176:179]
    s_waitcnt lgkmcnt(10)
    ds_read_b64 v[106:107], v246 offset:8456
    ds_read_b64 v[108:109], v246 offset:8384
    v_mfma_f32_16x16x32_bf16 v[176:179], v[156:159], v[88:91], v[176:179]
    s_waitcnt lgkmcnt(10)
    ds_read_b64 v[110:111], v246 offset:8392
    v_mfma_f32_16x16x32_bf16 v[176:179], v[160:163], v[92:95], v[176:179]
    s_waitcnt lgkmcnt(8)
    v_cmp_ge_u32 vcc, 0, v239
    v_mfma_f32_16x16x32_bf16 v[176:179], v[164:167], v[96:99], v[176:179]
    s_cbranch_vccnz L_retry0
L_back0:
    v_mfma_f32_16x16x32_bf16 v[180:183], v[136:139], v[32:35], 0
    ds_read_b64 v[112:113], v246 offset:8320
    ds_read_b64 v[114:115], v246 offset:8328
    v_mfma_f32_16x16x32_bf16 v[180:183], v[140:143], v[36:39], v[180:183]
    ds_read_b64 v[116:117], v246 offset:8256
    ds_read_b64 v[118:119], v246 offset:8264
    v_mfma_f32_16x16x32_bf16 v[180:183], v[144:147], v[40:43], v[180:183]
    v_sub_f32 v172, v172, v176
    v_sub_f32 v173, v173, v177
    v_sub_f32 v174, v174, v178
    v_sub_f32 v175, v175, v179
    v_mfma_f32_16x16x32_bf16 v[180:183], v[148:151], v[44:47], v[180:183]
    s_waitcnt lgkmcnt(11)
    v_fma_f32 v172, v196, v172, v176
    v_fma_f32 v173, v197, v173, v177
    v_fma_f32 v174, v198, v174, v178
    v_fma_f32 v175, v199, v175, v179
    v_mfma_f32_16x16x32_bf16 v[180:183], v[152:155], v[48:51], v[180:183]
    v_cvt_pk_bf16_f32 v240, v172, v173
    v_cvt_pk_bf16_f32 v241, v174, v175
    v_mov_b32 v242, 1
    v_mfma_f32_16x16x32_bf16 v[180:183], v[156:159], v[52:55], v[180:183]
    ds_write_addtid_b32 v240 offset:45824
    ds_write_addtid_b32 v241 offset:46080
    ds_write_addtid_b32 v242 offset:49920
    v_mfma_f32_16x16x32_bf16 v[180:183], v[160:163], v[56:59], v[180:183]
    ds_read_b64 v[120:121], v246 offset:8192
    ds_read_b64 v[122:123], v246 offset:8200
    v_mfma_f32_16x16x32_bf16 v[180:183], v[164:167], v[60:63], v[180:183]
    s_wakeup
    ds_read_b64 v[124:125], v246 offset:8128
    ds_read_b64 v[126:127], v246 offset:8136
    v_mfma_f32_16x16x32_bf16 v[216:219], v[136:139], v[248:251], 0
    s_waitcnt lgkmcnt(14)
    ds_read_b64 v[128:129], v246 offset:8064
    ds_read_b64 v[130:131], v246 offset:8072
    v_mfma_f32_16x16x32_bf16 v[220:223], v[224:227], v[252:255], 0
    ds_read_b64 v[132:133], v246 offset:8000
    ds_read_b64 v[134:135], v246 offset:8008
    v_mfma_f32_16x16x32_bf16 v[184:187], v[136:139], v[100:103], 0
    s_waitcnt lgkmcnt(14)
    ds_read_b128 v[136:139], v245 offset:992
    v_mfma_f32_16x16x32_bf16 v[184:187], v[140:143], v[104:107], v[184:187]
    ds_read_b128 v[140:143], v245 offset:928
    v_mfma_f32_16x16x32_bf16 v[184:187], v[144:147], v[108:111], v[184:187]
    s_waitcnt lgkmcnt(14)
    ds_read_b128 v[144:147], v245 offset:864
    v_mfma_f32_16x16x32_bf16 v[184:187], v[148:151], v[112:115], v[184:187]
    s_waitcnt lgkmcnt(14)
    ds_read_b128 v[148:151], v245 offset:800
    v_cvt_pk_bf16_f32 v200, v220, v216
    v_mfma_f32_16x16x32_bf16 v[184:187], v[152:155], v[116:119], v[184:187]
    s_waitcnt lgkmcnt(10)
    ds_read_b128 v[152:155], v245 offset:736
    v_cvt_pk_bf16_f32 v201, v221, v217
    v_mfma_f32_16x16x32_bf16 v[184:187], v[156:159], v[120:123], v[184:187]
    s_waitcnt lgkmcnt(9)
    ds_read_b128 v[156:159], v245 offset:672
    v_cvt_pk_bf16_f32 v202, v222, v218
    v_mfma_f32_16x16x32_bf16 v[184:187], v[160:163], v[124:127], v[184:187]
    s_wakeup
    s_waitcnt lgkmcnt(8)
    ds_read_b128 v[160:163], v245 offset:608
    v_cvt_pk_bf16_f32 v203, v223, v219
    v_mfma_f32_16x16x32_bf16 v[184:187], v[164:167], v[128:131], v[184:187]
    s_waitcnt lgkmcnt(6)
    ds_read_b128 v[164:167], v245 offset:544
    v_mfma_f32_16x16x32_bf16 v[180:183], v[136:139], v[0:3], v[180:183]
    ds_read_b128 v[168:171], v245 offset:480
    ds_read_b128 v[224:227], v245 offset:976
    v_mfma_f32_16x16x32_bf16 v[184:187], v[136:139], v[68:71], v[184:187]
    s_waitcnt lgkmcnt(8)
    v_mfma_f32_16x16x32_bf16 v[180:183], v[140:143], v[4:7], v[180:183]
    v_mfma_f32_16x16x32_bf16 v[184:187], v[140:143], v[72:75], v[184:187]
    s_waitcnt lgkmcnt(7)
    v_mfma_f32_16x16x32_bf16 v[180:183], v[144:147], v[8:11], v[180:183]
    v_mfma_f32_16x16x32_bf16 v[184:187], v[144:147], v[76:79], v[184:187]
    s_waitcnt lgkmcnt(6)
    v_mfma_f32_16x16x32_bf16 v[180:183], v[148:151], v[12:15], v[180:183]
    v_mfma_f32_16x16x32_bf16 v[184:187], v[148:151], v[80:83], v[184:187]
    s_waitcnt lgkmcnt(5)
    v_mfma_f32_16x16x32_bf16 v[180:183], v[152:155], v[16:19], v[180:183]
    v_mfma_f32_16x16x32_bf16 v[184:187], v[152:155], v[84:87], v[184:187]
    s_waitcnt lgkmcnt(4)
    v_mfma_f32_16x16x32_bf16 v[180:183], v[156:159], v[20:23], v[180:183]
    v_mfma_f32_16x16x32_bf16 v[184:187], v[156:159], v[88:91], v[184:187]
    s_waitcnt lgkmcnt(3)
    v_mfma_f32_16x16x32_bf16 v[180:183], v[160:163], v[24:27], v[180:183]
    ds_read_b32 v239, v238
    ds_read_b128 v[196:199], v237 offset:1024
    v_mfma_f32_16x16x32_bf16 v[184:187], v[160:163], v[92:95], v[184:187]
    s_waitcnt lgkmcnt(4)
    v_mfma_f32_16x16x32_bf16 v[180:183], v[164:167], v[28:31], v[180:183]
    v_mfma_f32_16x16x32_bf16 v[184:187], v[164:167], v[96:99], v[184:187]
    v_mfma_f32_16x16x32_bf16 v[172:175], v[136:139], v[32:35], 0
    v_mfma_f32_16x16x32_bf16 v[176:179], v[136:139], v[100:103], 0
    s_waitcnt lgkmcnt(1)
    v_cmp_ge_u32 vcc, 1, v239
    v_mfma_f32_16x16x32_bf16 v[216:219], v[136:139], v[248:251], 0
    s_cbranch_vccnz L_retry1
L_back1:
    ds_read_b128 v[136:139], v245 offset:1504
    v_mfma_f32_16x16x32_bf16 v[220:223], v[224:227], v[252:255], 0
    v_sub_f32 v180, v180, v184
    v_sub_f32 v181, v181, v185
    v_mfma_f32_16x16x32_bf16 v[172:175], v[140:143], v[36:39], v[172:175]
    v_sub_f32 v182, v182, v186
    v_sub_f32 v183, v183, v187
    v_mfma_f32_16x16x32_bf16 v[176:179], v[140:143], v[104:107], v[176:179]
    s_waitcnt lgkmcnt(1)
    ds_read_b128 v[140:143], v245 offset:1440
    v_fma_f32 v180, v196, v180, v184
    v_mfma_f32_16x16x32_bf16 v[172:175], v[144:147], v[40:43], v[172:175]
    v_fma_f32 v181, v197, v181, v185
    v_fma_f32 v182, v198, v182, v186
    v_mfma_f32_16x16x32_bf16 v[176:179], v[144:147], v[108:111], v[176:179]
    ds_read_b128 v[144:147], v245 offset:1376
    v_cvt_pk_bf16_f32 v204, v220, v216
    v_mfma_f32_16x16x32_bf16 v[172:175], v[148:151], v[44:47], v[172:175]
    v_cvt_pk_bf16_f32 v205, v221, v217
    v_cvt_pk_bf16_f32 v206, v222, v218
    v_mfma_f32_16x16x32_bf16 v[176:179], v[148:151], v[112:115], v[176:179]
    ds_read_b128 v[148:151], v245 offset:1312
    v_cvt_pk_bf16_f32 v207, v223, v219
    v_mfma_f32_16x16x32_bf16 v[172:175], v[152:155], v[48:51], v[172:175]
    v_fma_f32 v183, v199, v183, v187
    v_cvt_pk_bf16_f32 v240, v180, v181
    v_mfma_f32_16x16x32_bf16 v[176:179], v[152:155], v[116:119], v[176:179]
    ds_read_b128 v[152:155], v245 offset:1248
    v_cvt_pk_bf16_f32 v241, v182, v183
    v_mfma_f32_16x16x32_bf16 v[172:175], v[156:159], v[52:55], v[172:175]
    v_mov_b32 v242, 2
    v_mfma_f32_16x16x32_bf16 v[176:179], v[156:159], v[120:123], v[176:179]
    ds_read_b128 v[156:159], v245 offset:1184
    ds_write_addtid_b32 v240 offset:46336
    v_mfma_f32_16x16x32_bf16 v[172:175], v[160:163], v[56:59], v[172:175]
    ds_write_addtid_b32 v241 offset:46592
    ds_write_addtid_b32 v242 offset:49920
    v_mfma_f32_16x16x32_bf16 v[176:179], v[160:163], v[124:127], v[176:179]
    ds_read_b128 v[160:163], v245 offset:1120
    v_mfma_f32_16x16x32_bf16 v[172:175], v[164:167], v[60:63], v[172:175]
    s_wakeup
    v_mfma_f32_16x16x32_bf16 v[176:179], v[164:167], v[128:131], v[176:179]
    ds_read_b128 v[164:167], v245 offset:1056
    v_mfma_f32_16x16x32_bf16 v[172:175], v[168:171], v[64:67], v[172:175]
    v_mfma_f32_16x16x32_bf16 v[176:179], v[168:171], v[132:135], v[176:179]
    s_waitcnt lgkmcnt(10)
    v_mfma_f32_16x16x32_bf16 v[172:175], v[136:139], v[0:3], v[172:175]
    ds_read_b128 v[168:171], v245 offset:992
    ds_read_b128 v[224:227], v245 offset:1488
    v_mfma_f32_16x16x32_bf16 v[176:179], v[136:139], v[68:71], v[176:179]
    s_waitcnt lgkmcnt(11)
    v_mfma_f32_16x16x32_bf16 v[172:175], v[140:143], v[4:7], v[172:175]
    v_mfma_f32_16x16x32_bf16 v[176:179], v[140:143], v[72:75], v[176:179]
    s_waitcnt lgkmcnt(10)
    v_mfma_f32_16x16x32_bf16 v[172:175], v[144:147], v[8:11], v[172:175]
    v_mfma_f32_16x16x32_bf16 v[176:179], v[144:147], v[76:79], v[176:179]
    s_wakeup
    s_waitcnt lgkmcnt(9)
    v_mfma_f32_16x16x32_bf16 v[172:175], v[148:151], v[12:15], v[172:175]
    v_mfma_f32_16x16x32_bf16 v[176:179], v[148:151], v[80:83], v[176:179]
    s_waitcnt lgkmcnt(8)
    v_mfma_f32_16x16x32_bf16 v[172:175], v[152:155], v[16:19], v[172:175]
    v_mfma_f32_16x16x32_bf16 v[176:179], v[152:155], v[84:87], v[176:179]
    s_waitcnt lgkmcnt(7)
    v_mfma_f32_16x16x32_bf16 v[172:175], v[156:159], v[20:23], v[172:175]
    v_mfma_f32_16x16x32_bf16 v[176:179], v[156:159], v[88:91], v[176:179]
    s_waitcnt lgkmcnt(3)
    v_mfma_f32_16x16x32_bf16 v[172:175], v[160:163], v[24:27], v[172:175]
    ds_read_b32 v239, v238
    ds_read_b128 v[196:199], v237 offset:2048
    v_mfma_f32_16x16x32_bf16 v[176:179], v[160:163], v[92:95], v[176:179]
    s_waitcnt lgkmcnt(4)
    ds_read2st64_b32 v[188:189], v236 offset0:0 offset1:1
    ds_read2st64_b32 v[190:191], v236 offset0:2 offset1:3
    v_mfma_f32_16x16x32_bf16 v[172:175], v[164:167], v[28:31], v[172:175]
    ds_read2st64_b32 v[192:193], v243 offset0:0 offset1:1
    ds_read2st64_b32 v[194:195], v243 offset0:2 offset1:3
    v_mfma_f32_16x16x32_bf16 v[176:179], v[164:167], v[96:99], v[176:179]
    v_mfma_f32_16x16x32_bf16 v[180:183], v[136:139], v[32:35], 0
    v_mfma_f32_16x16x32_bf16 v[184:187], v[136:139], v[100:103], 0
    v_mfma_f32_16x16x32_bf16 v[216:219], v[136:139], v[248:251], 0
    s_waitcnt lgkmcnt(6)
    ds_read_b128 v[136:139], v245 offset:2016
    v_mfma_f32_16x16x32_bf16 v[220:223], v[224:227], v[252:255], 0
    s_waitcnt lgkmcnt(6)
    v_cmp_ge_u32 vcc, 2, v239
    v_mfma_f32_16x16x32_bf16 v[180:183], v[140:143], v[36:39], v[180:183]
    s_cbranch_vccnz L_retry2
L_back2:
    s_waitcnt lgkmcnt(4)
    v_add_f32 v172, v172, v188
    v_add_f32 v173, v173, v189
    v_mfma_f32_16x16x32_bf16 v[184:187], v[140:143], v[104:107], v[184:187]
    s_waitcnt lgkmcnt(3)
    ds_read_b128 v[140:143], v245 offset:1952
    v_add_f32 v174, v174, v190
    v_mfma_f32_16x16x32_bf16 v[180:183], v[144:147], v[40:43], v[180:183]
    s_waitcnt lgkmcnt(3)
    v_add_f32 v175, v175, v191
    v_add_f32 v176, v176, v192
    v_mfma_f32_16x16x32_bf16 v[184:187], v[144:147], v[108:111], v[184:187]
    ds_read_b128 v[144:147], v245 offset:1888
    v_cvt_pk_bf16_f32 v208, v220, v216
    v_mfma_f32_16x16x32_bf16 v[180:183], v[148:151], v[44:47], v[180:183]
    v_cvt_pk_bf16_f32 v209, v221, v217
    v_cvt_pk_bf16_f32 v210, v222, v218
    v_mfma_f32_16x16x32_bf16 v[184:187], v[148:151], v[112:115], v[184:187]
    ds_read_b128 v[148:151], v245 offset:1824
    v_cvt_pk_bf16_f32 v211, v223, v219
    v_mfma_f32_16x16x32_bf16 v[180:183], v[152:155], v[48:51], v[180:183]
    s_waitcnt lgkmcnt(4)
    v_add_f32 v177, v177, v193
    v_add_f32 v178, v178, v194
    v_mfma_f32_16x16x32_bf16 v[184:187], v[152:155], v[116:119], v[184:187]
    ds_read_b128 v[152:155], v245 offset:1760
    v_add_f32 v179, v179, v195
    v_mfma_f32_16x16x32_bf16 v[180:183], v[156:159], v[52:55], v[180:183]
    v_sub_f32 v172, v172, v176
    v_sub_f32 v173, v173, v177
    v_mfma_f32_16x16x32_bf16 v[184:187], v[156:159], v[120:123], v[184:187]
    ds_read_b128 v[156:159], v245 offset:1696
    v_sub_f32 v174, v174, v178
    v_mfma_f32_16x16x32_bf16 v[180:183], v[160:163], v[56:59], v[180:183]
    v_sub_f32 v175, v175, v179
    v_fma_f32 v172, v196, v172, v176
    v_mfma_f32_16x16x32_bf16 v[184:187], v[160:163], v[124:127], v[184:187]
    ds_read_b128 v[160:163], v245 offset:1632
    v_fma_f32 v173, v197, v173, v177
    v_mfma_f32_16x16x32_bf16 v[180:183], v[164:167], v[60:63], v[180:183]
    v_fma_f32 v174, v198, v174, v178
    v_fma_f32 v175, v199, v175, v179
    v_mfma_f32_16x16x32_bf16 v[184:187], v[164:167], v[128:131], v[184:187]
    ds_read_b128 v[164:167], v245 offset:1568
    v_cvt_pk_bf16_f32 v240, v172, v173
    v_mfma_f32_16x16x32_bf16 v[180:183], v[168:171], v[64:67], v[180:183]
    v_cvt_pk_bf16_f32 v241, v174, v175
    v_mov_b32 v242, 3
    v_mfma_f32_16x16x32_bf16 v[184:187], v[168:171], v[132:135], v[184:187]
    s_waitcnt lgkmcnt(7)
    ds_write_addtid_b32 v240 offset:46848
    ds_write_addtid_b32 v241 offset:47104
    v_mfma_f32_16x16x32_bf16 v[180:183], v[136:139], v[0:3], v[180:183]
    ds_write_addtid_b32 v242 offset:49920
    ds_read_b128 v[168:171], v245 offset:1504
    v_mfma_f32_16x16x32_bf16 v[184:187], v[136:139], v[68:71], v[184:187]
    s_waitcnt lgkmcnt(10)
    ds_read_b128 v[224:227], v245 offset:2000
    v_mfma_f32_16x16x32_bf16 v[180:183], v[140:143], v[4:7], v[180:183]
    s_wakeup
    v_mfma_f32_16x16x32_bf16 v[184:187], v[140:143], v[72:75], v[184:187]
    s_waitcnt lgkmcnt(10)
    v_mfma_f32_16x16x32_bf16 v[180:183], v[144:147], v[8:11], v[180:183]
    v_mfma_f32_16x16x32_bf16 v[184:187], v[144:147], v[76:79], v[184:187]
    s_waitcnt lgkmcnt(9)
    v_mfma_f32_16x16x32_bf16 v[180:183], v[148:151], v[12:15], v[180:183]
    v_mfma_f32_16x16x32_bf16 v[184:187], v[148:151], v[80:83], v[184:187]
    s_waitcnt lgkmcnt(8)
    v_mfma_f32_16x16x32_bf16 v[180:183], v[152:155], v[16:19], v[180:183]
    v_mfma_f32_16x16x32_bf16 v[184:187], v[152:155], v[84:87], v[184:187]
    s_waitcnt lgkmcnt(7)
    v_mfma_f32_16x16x32_bf16 v[180:183], v[156:159], v[20:23], v[180:183]
    v_mfma_f32_16x16x32_bf16 v[184:187], v[156:159], v[88:91], v[184:187]
    s_wakeup
    s_waitcnt lgkmcnt(6)
    v_mfma_f32_16x16x32_bf16 v[180:183], v[160:163], v[24:27], v[180:183]
    ds_read_b32 v239, v238
    ds_read_b128 v[196:199], v237 offset:3072
    v_mfma_f32_16x16x32_bf16 v[184:187], v[160:163], v[92:95], v[184:187]
    s_waitcnt lgkmcnt(7)
    ds_read2st64_b32 v[188:189], v236 offset0:24 offset1:25
    ds_read2st64_b32 v[190:191], v236 offset0:26 offset1:27
    v_mfma_f32_16x16x32_bf16 v[180:183], v[164:167], v[28:31], v[180:183]
    ds_read2st64_b32 v[192:193], v243 offset0:24 offset1:25
    ds_read2st64_b32 v[194:195], v243 offset0:26 offset1:27
    v_mfma_f32_16x16x32_bf16 v[184:187], v[164:167], v[96:99], v[184:187]
    v_mfma_f32_16x16x32_bf16 v[172:175], v[136:139], v[32:35], 0
    v_mfma_f32_16x16x32_bf16 v[176:179], v[136:139], v[100:103], 0
    v_mfma_f32_16x16x32_bf16 v[216:219], v[136:139], v[248:251], 0
    s_waitcnt lgkmcnt(6)
    ds_read_b128 v[136:139], v245 offset:2528
    v_mfma_f32_16x16x32_bf16 v[220:223], v[224:227], v[252:255], 0
    s_waitcnt lgkmcnt(6)
    v_cmp_ge_u32 vcc, 3, v239
    v_mfma_f32_16x16x32_bf16 v[172:175], v[140:143], v[36:39], v[172:175]
    s_cbranch_vccnz L_retry3
L_back3:
    s_waitcnt lgkmcnt(4)
    v_add_f32 v180, v180, v188
    v_add_f32 v181, v181, v189
    v_mfma_f32_16x16x32_bf16 v[176:179], v[140:143], v[104:107], v[176:179]
    s_waitcnt lgkmcnt(3)
    ds_read_b128 v[140:143], v245 offset:2464
    v_add_f32 v182, v182, v190
    v_mfma_f32_16x16x32_bf16 v[172:175], v[144:147], v[40:43], v[172:175]
    s_waitcnt lgkmcnt(3)
    v_add_f32 v183, v183, v191
    v_add_f32 v184, v184, v192
    v_mfma_f32_16x16x32_bf16 v[176:179], v[144:147], v[108:111], v[176:179]
    ds_read_b128 v[144:147], v245 offset:2400
    v_cvt_pk_bf16_f32 v212, v220, v216
    v_mfma_f32_16x16x32_bf16 v[172:175], v[148:151], v[44:47], v[172:175]
    v_cvt_pk_bf16_f32 v213, v221, v217
    v_cvt_pk_bf16_f32 v214, v222, v218
    v_mfma_f32_16x16x32_bf16 v[176:179], v[148:151], v[112:115], v[176:179]
    ds_read_b128 v[148:151], v245 offset:2336
    v_cvt_pk_bf16_f32 v215, v223, v219
    v_mfma_f32_16x16x32_bf16 v[172:175], v[152:155], v[48:51], v[172:175]
    s_waitcnt lgkmcnt(4)
    v_add_f32 v185, v185, v193
    v_add_f32 v186, v186, v194
    v_mfma_f32_16x16x32_bf16 v[176:179], v[152:155], v[116:119], v[176:179]
    ds_read_b128 v[152:155], v245 offset:2272
    v_add_f32 v187, v187, v195
    v_mfma_f32_16x16x32_bf16 v[172:175], v[156:159], v[52:55], v[172:175]
    v_sub_f32 v180, v180, v184
    v_sub_f32 v181, v181, v185
    v_mfma_f32_16x16x32_bf16 v[176:179], v[156:159], v[120:123], v[176:179]
    ds_read_b128 v[156:159], v245 offset:2208
    v_sub_f32 v182, v182, v186
    v_mfma_f32_16x16x32_bf16 v[172:175], v[160:163], v[56:59], v[172:175]
    v_sub_f32 v183, v183, v187
    v_fma_f32 v180, v196, v180, v184
    v_mfma_f32_16x16x32_bf16 v[176:179], v[160:163], v[124:127], v[176:179]
    ds_read_b128 v[160:163], v245 offset:2144
    v_fma_f32 v181, v197, v181, v185
    v_mfma_f32_16x16x32_bf16 v[172:175], v[164:167], v[60:63], v[172:175]
    v_fma_f32 v182, v198, v182, v186
    v_fma_f32 v183, v199, v183, v187
    v_mfma_f32_16x16x32_bf16 v[176:179], v[164:167], v[128:131], v[176:179]
    ds_read_b128 v[164:167], v245 offset:2080
    v_cvt_pk_bf16_f32 v240, v180, v181
    v_mfma_f32_16x16x32_bf16 v[172:175], v[168:171], v[64:67], v[172:175]
    v_cvt_pk_bf16_f32 v241, v182, v183
    v_mov_b32 v242, 4
    v_mfma_f32_16x16x32_bf16 v[176:179], v[168:171], v[132:135], v[176:179]
    s_waitcnt lgkmcnt(7)
    ds_write_addtid_b32 v240 offset:47360
    ds_write_addtid_b32 v241 offset:47616
    v_mfma_f32_16x16x32_bf16 v[172:175], v[136:139], v[0:3], v[172:175]
    ds_write_addtid_b32 v242 offset:49920
    ds_read_b128 v[168:171], v245 offset:2016
    v_mfma_f32_16x16x32_bf16 v[176:179], v[136:139], v[68:71], v[176:179]
    s_waitcnt lgkmcnt(10)
    ds_read_b128 v[216:219], v247 offset:1804
    ds_read_b128 v[220:223], v247 offset:9740
    v_mfma_f32_16x16x32_bf16 v[172:175], v[140:143], v[4:7], v[172:175]
    s_wakeup
    ds_read_b128 v[232:235], v245 offset:480
    ds_read_b64 v[248:249], v246 offset:0
    v_mfma_f32_16x16x32_bf16 v[176:179], v[140:143], v[72:75], v[176:179]
    s_waitcnt lgkmcnt(13)
    ds_read_b64 v[250:251], v246 offset:8
    ds_read_b64 v[252:253], v246 offset:7936
    v_mfma_f32_16x16x32_bf16 v[172:175], v[144:147], v[8:11], v[172:175]
    ds_read_b64 v[254:255], v246 offset:7944
    v_mfma_f32_16x16x32_bf16 v[176:179], v[144:147], v[76:79], v[176:179]
    s_waitcnt lgkmcnt(14)
    v_mfma_f32_16x16x32_bf16 v[172:175], v[148:151], v[12:15], v[172:175]
    v_mfma_f32_16x16x32_bf16 v[176:179], v[148:151], v[80:83], v[176:179]
    s_waitcnt lgkmcnt(6)
    v_mfma_f32_16x16x32_bf16 v[172:175], v[216:219], v[200:203], v[172:175]
    s_waitcnt lgkmcnt(5)
    v_mfma_f32_16x16x32_bf16 v[176:179], v[220:223], v[200:203], v[176:179]
    v_mfma_f32_16x16x32_bf16 v[172:175], v[152:155], v[16:19], v[172:175]
    v_mfma_f32_16x16x32_bf16 v[176:179], v[152:155], v[84:87], v[176:179]
    s_wakeup
    v_mfma_f32_16x16x32_bf16 v[172:175], v[156:159], v[20:23], v[172:175]
    v_mfma_f32_16x16x32_bf16 v[176:179], v[156:159], v[88:91], v[176:179]
    v_mfma_f32_16x16x32_bf16 v[172:175], v[160:163], v[24:27], v[172:175]
    v_mfma_f32_16x16x32_bf16 v[176:179], v[160:163], v[92:95], v[176:179]
    v_mfma_f32_16x16x32_bf16 v[172:175], v[164:167], v[28:31], v[172:175]
    ds_read_b32 v239, v238
    ds_read_b128 v[196:199], v237 offset:4096
    v_mfma_f32_16x16x32_bf16 v[176:179], v[164:167], v[96:99], v[176:179]
    s_waitcnt lgkmcnt(4)
    ds_read2st64_b32 v[188:189], v236 offset0:48 offset1:49
    ds_read2st64_b32 v[190:191], v236 offset0:50 offset1:51
    v_mfma_f32_16x16x32_bf16 v[172:175], v[232:235], v[248:251], v[172:175]
    s_waitcnt lgkmcnt(4)
    ds_read2st64_b32 v[192:193], v243 offset0:48 offset1:49
    ds_read2st64_b32 v[194:195], v243 offset0:50 offset1:51
    v_mfma_f32_16x16x32_bf16 v[176:179], v[232:235], v[252:255], v[176:179]
    v_mfma_f32_16x16x32_bf16 v[180:183], v[136:139], v[32:35], 0
    v_mfma_f32_16x16x32_bf16 v[184:187], v[136:139], v[100:103], 0
    ds_read_b128 v[136:139], v245 offset:3040
    v_mfma_f32_16x16x32_bf16 v[180:183], v[140:143], v[36:39], v[180:183]
    v_mfma_f32_16x16x32_bf16 v[184:187], v[140:143], v[104:107], v[184:187]
    s_waitcnt lgkmcnt(6)
    ds_read_b128 v[140:143], v245 offset:2976
    v_cmp_ge_u32 vcc, 4, v239
    v_mfma_f32_16x16x32_bf16 v[180:183], v[144:147], v[40:43], v[180:183]
    s_cbranch_vccnz L_retry4
L_back4:
    s_waitcnt lgkmcnt(5)
    v_add_f32 v172, v172, v188
    v_add_f32 v173, v173, v189
    v_mfma_f32_16x16x32_bf16 v[184:187], v[144:147], v[108:111], v[184:187]
    s_waitcnt lgkmcnt(4)
    ds_read_b128 v[144:147], v245 offset:2912
    v_add_f32 v174, v174, v190
    v_mfma_f32_16x16x32_bf16 v[180:183], v[148:151], v[44:47], v[180:183]
    s_waitcnt lgkmcnt(4)
    v_add_f32 v175, v175, v191
    v_add_f32 v176, v176, v192
    v_mfma_f32_16x16x32_bf16 v[184:187], v[148:151], v[112:115], v[184:187]
    ds_read_b128 v[148:151], v245 offset:2848
    v_add_f32 v177, v177, v193
    v_mfma_f32_16x16x32_bf16 v[180:183], v[152:155], v[48:51], v[180:183]
    s_waitcnt lgkmcnt(4)
    v_add_f32 v178, v178, v194
    v_add_f32 v179, v179, v195
    v_mfma_f32_16x16x32_bf16 v[184:187], v[152:155], v[116:119], v[184:187]
    ds_read_b128 v[152:155], v245 offset:2784
    v_sub_f32 v172, v172, v176
    v_mfma_f32_16x16x32_bf16 v[180:183], v[156:159], v[52:55], v[180:183]
    ds_read_b128 v[216:219], v247 offset:1804
    ds_read_b128 v[220:223], v247 offset:9740
    v_mfma_f32_16x16x32_bf16 v[184:187], v[156:159], v[120:123], v[184:187]
    ds_read_b128 v[156:159], v245 offset:2720
    ds_read_b128 v[224:227], v247 offset:1740
    v_mfma_f32_16x16x32_bf16 v[180:183], v[160:163], v[56:59], v[180:183]
    ds_read_b128 v[228:231], v247 offset:9676
    ds_read_b128 v[232:235], v245 offset:992
    v_mfma_f32_16x16x32_bf16 v[184:187], v[160:163], v[124:127], v[184:187]
    ds_read_b128 v[160:163], v245 offset:2656
    v_sub_f32 v173, v173, v177
    v_mfma_f32_16x16x32_bf16 v[180:183], v[164:167], v[60:63], v[180:183]
    v_sub_f32 v174, v174, v178
    v_sub_f32 v175, v175, v179
    v_mfma_f32_16x16x32_bf16 v[184:187], v[164:167], v[128:131], v[184:187]
    ds_read_b128 v[164:167], v245 offset:2592
    v_fma_f32 v172, v196, v172, v176
    v_mfma_f32_16x16x32_bf16 v[180:183], v[168:171], v[64:67], v[180:183]
    v_fma_f32 v173, v197, v173, v177
    v_fma_f32 v174, v198, v174, v178
    v_mfma_f32_16x16x32_bf16 v[184:187], v[168:171], v[132:135], v[184:187]
    s_waitcnt lgkmcnt(12)
    v_fma_f32 v175, v199, v175, v179
    v_cvt_pk_bf16_f32 v240, v172, v173
    v_mfma_f32_16x16x32_bf16 v[180:183], v[136:139], v[0:3], v[180:183]
    v_cvt_pk_bf16_f32 v241, v174, v175
    v_mov_b32 v242, 5
    v_mfma_f32_16x16x32_bf16 v[184:187], v[136:139], v[68:71], v[184:187]
    s_waitcnt lgkmcnt(11)
    ds_write_addtid_b32 v240 offset:47872
    ds_write_addtid_b32 v241 offset:48128
    v_mfma_f32_16x16x32_bf16 v[180:183], v[140:143], v[4:7], v[180:183]
    ds_write_addtid_b32 v242 offset:49920
    ds_read_b128 v[168:171], v245 offset:2528
    v_mfma_f32_16x16x32_bf16 v[184:187], v[140:143], v[72:75], v[184:187]
    s_waitcnt lgkmcnt(14)
    v_mfma_f32_16x16x32_bf16 v[180:183], v[144:147], v[8:11], v[180:183]
    s_wakeup
    v_mfma_f32_16x16x32_bf16 v[184:187], v[144:147], v[76:79], v[184:187]
    s_waitcnt lgkmcnt(13)
    v_mfma_f32_16x16x32_bf16 v[180:183], v[148:151], v[12:15], v[180:183]
    v_mfma_f32_16x16x32_bf16 v[184:187], v[148:151], v[80:83], v[184:187]
    s_waitcnt lgkmcnt(11)
    v_mfma_f32_16x16x32_bf16 v[180:183], v[216:219], v[204:207], v[180:183]
    s_waitcnt lgkmcnt(10)
    v_mfma_f32_16x16x32_bf16 v[184:187], v[220:223], v[204:207], v[184:187]
    s_waitcnt lgkmcnt(8)
    v_mfma_f32_16x16x32_bf16 v[180:183], v[224:227], v[200:203], v[180:183]
    s_waitcnt lgkmcnt(7)
    v_mfma_f32_16x16x32_bf16 v[184:187], v[228:231], v[200:203], v[184:187]
    v_mfma_f32_16x16x32_bf16 v[180:183], v[152:155], v[16:19], v[180:183]
    v_mfma_f32_16x16x32_bf16 v[184:187], v[152:155], v[84:87], v[184:187]
    s_wakeup
    v_mfma_f32_16x16x32_bf16 v[180:183], v[156:159], v[20:23], v[180:183]
    v_mfma_f32_16x16x32_bf16 v[184:187], v[156:159], v[88:91], v[184:187]
    s_waitcnt lgkmcnt(5)
    v_mfma_f32_16x16x32_bf16 v[180:183], v[160:163], v[24:27], v[180:183]
    v_mfma_f32_16x16x32_bf16 v[184:187], v[160:163], v[92:95], v[184:187]
    s_waitcnt lgkmcnt(4)
    v_mfma_f32_16x16x32_bf16 v[180:183], v[164:167], v[28:31], v[180:183]
    ds_read_b32 v239, v238
    ds_read_b128 v[196:199], v237 offset:5120
    v_mfma_f32_16x16x32_bf16 v[184:187], v[164:167], v[96:99], v[184:187]
    ds_read2st64_b32 v[188:189], v236 offset0:72 offset1:73
    ds_read2st64_b32 v[190:191], v236 offset0:74 offset1:75
    v_mfma_f32_16x16x32_bf16 v[180:183], v[232:235], v[248:251], v[180:183]
    ds_read2st64_b32 v[192:193], v243 offset0:72 offset1:73
    ds_read2st64_b32 v[194:195], v243 offset0:74 offset1:75
    v_mfma_f32_16x16x32_bf16 v[184:187], v[232:235], v[252:255], v[184:187]
    v_mfma_f32_16x16x32_bf16 v[172:175], v[136:139], v[32:35], 0
    v_mfma_f32_16x16x32_bf16 v[176:179], v[136:139], v[100:103], 0
    ds_read_b128 v[136:139], v245 offset:3552
    v_mfma_f32_16x16x32_bf16 v[172:175], v[140:143], v[36:39], v[172:175]
    v_mfma_f32_16x16x32_bf16 v[176:179], v[140:143], v[104:107], v[176:179]
    s_waitcnt lgkmcnt(6)
    ds_read_b128 v[140:143], v245 offset:3488
    v_cmp_ge_u32 vcc, 5, v239
    v_mfma_f32_16x16x32_bf16 v[172:175], v[144:147], v[40:43], v[172:175]
    s_cbranch_vccnz L_retry5
L_back5:
    s_waitcnt lgkmcnt(5)
    v_add_f32 v180, v180, v188
    v_add_f32 v181, v181, v189
    v_mfma_f32_16x16x32_bf16 v[176:179], v[144:147], v[108:111], v[176:179]
    s_waitcnt lgkmcnt(4)
    ds_read_b128 v[144:147], v245 offset:3424
    v_add_f32 v182, v182, v190
    v_mfma_f32_16x16x32_bf16 v[172:175], v[148:151], v[44:47], v[172:175]
    s_waitcnt lgkmcnt(4)
    v_add_f32 v183, v183, v191
    v_add_f32 v184, v184, v192
    v_mfma_f32_16x16x32_bf16 v[176:179], v[148:151], v[112:115], v[176:179]
    ds_read_b128 v[148:151], v245 offset:3360
    v_add_f32 v185, v185, v193
    v_mfma_f32_16x16x32_bf16 v[172:175], v[152:155], v[48:51], v[172:175]
    s_waitcnt lgkmcnt(4)
    v_add_f32 v186, v186, v194
    v_add_f32 v187, v187, v195
    v_mfma_f32_16x16x32_bf16 v[176:179], v[152:155], v[116:119], v[176:179]
    ds_read_b128 v[152:155], v245 offset:3296
    v_sub_f32 v180, v180, v184
    v_mfma_f32_16x16x32_bf16 v[172:175], v[156:159], v[52:55], v[172:175]
    ds_read_b128 v[216:219], v247 offset:1804
    ds_read_b128 v[220:223], v247 offset:9740
    v_mfma_f32_16x16x32_bf16 v[176:179], v[156:159], v[120:123], v[176:179]
    ds_read_b128 v[156:159], v245 offset:3232
    ds_read_b128 v[224:227], v247 offset:1740
    v_mfma_f32_16x16x32_bf16 v[172:175], v[160:163], v[56:59], v[172:175]
    ds_read_b128 v[228:231], v247 offset:9676
    ds_read_b128 v[232:235], v245 offset:1504
    v_mfma_f32_16x16x32_bf16 v[176:179], v[160:163], v[124:127], v[176:179]
    ds_read_b128 v[160:163], v245 offset:3168
    v_sub_f32 v181, v181, v185
    v_mfma_f32_16x16x32_bf16 v[172:175], v[164:167], v[60:63], v[172:175]
    v_sub_f32 v182, v182, v186
    v_sub_f32 v183, v183, v187
    v_mfma_f32_16x16x32_bf16 v[176:179], v[164:167], v[128:131], v[176:179]
    ds_read_b128 v[164:167], v245 offset:3104
    v_fma_f32 v180, v196, v180, v184
    v_mfma_f32_16x16x32_bf16 v[172:175], v[168:171], v[64:67], v[172:175]
    v_fma_f32 v181, v197, v181, v185
    v_fma_f32 v182, v198, v182, v186
    v_mfma_f32_16x16x32_bf16 v[176:179], v[168:171], v[132:135], v[176:179]
    s_waitcnt lgkmcnt(12)
    v_fma_f32 v183, v199, v183, v187
    v_cvt_pk_bf16_f32 v240, v180, v181
    v_mfma_f32_16x16x32_bf16 v[172:175], v[136:139], v[0:3], v[172:175]
    v_cvt_pk_bf16_f32 v241, v182, v183
    v_mov_b32 v242, 6
    v_mfma_f32_16x16x32_bf16 v[176:179], v[136:139], v[68:71], v[176:179]
    s_waitcnt lgkmcnt(11)
    ds_write_addtid_b32 v240 offset:48384
    ds_write_addtid_b32 v241 offset:48640
    v_mfma_f32_16x16x32_bf16 v[172:175], v[140:143], v[4:7], v[172:175]
    ds_write_addtid_b32 v242 offset:49920
    ds_read_b128 v[168:171], v245 offset:3040
    v_mfma_f32_16x16x32_bf16 v[176:179], v[140:143], v[72:75], v[176:179]
    s_waitcnt lgkmcnt(14)
    v_mfma_f32_16x16x32_bf16 v[172:175], v[144:147], v[8:11], v[172:175]
    s_wakeup
    v_mfma_f32_16x16x32_bf16 v[176:179], v[144:147], v[76:79], v[176:179]
    s_waitcnt lgkmcnt(13)
    v_mfma_f32_16x16x32_bf16 v[172:175], v[148:151], v[12:15], v[172:175]
    v_mfma_f32_16x16x32_bf16 v[176:179], v[148:151], v[80:83], v[176:179]
    s_waitcnt lgkmcnt(11)
    v_mfma_f32_16x16x32_bf16 v[172:175], v[216:219], v[208:211], v[172:175]
    s_waitcnt lgkmcnt(10)
    v_mfma_f32_16x16x32_bf16 v[176:179], v[220:223], v[208:211], v[176:179]
    s_waitcnt lgkmcnt(8)
    ds_read_b128 v[216:219], v247 offset:1676
    ds_read_b128 v[220:223], v247 offset:9612
    v_mfma_f32_16x16x32_bf16 v[172:175], v[224:227], v[204:207], v[172:175]
    s_waitcnt lgkmcnt(9)
    v_mfma_f32_16x16x32_bf16 v[176:179], v[228:231], v[204:207], v[176:179]
    v_mfma_f32_16x16x32_bf16 v[172:175], v[152:155], v[16:19], v[172:175]
    v_mfma_f32_16x16x32_bf16 v[176:179], v[152:155], v[84:87], v[176:179]
    s_wakeup
    v_mfma_f32_16x16x32_bf16 v[172:175], v[156:159], v[20:23], v[172:175]
    v_mfma_f32_16x16x32_bf16 v[176:179], v[156:159], v[88:91], v[176:179]
    s_waitcnt lgkmcnt(7)
    v_mfma_f32_16x16x32_bf16 v[172:175], v[160:163], v[24:27], v[172:175]
    v_mfma_f32_16x16x32_bf16 v[176:179], v[160:163], v[92:95], v[176:179]
    s_waitcnt lgkmcnt(6)
    v_mfma_f32_16x16x32_bf16 v[172:175], v[164:167], v[28:31], v[172:175]
    v_mfma_f32_16x16x32_bf16 v[176:179], v[164:167], v[96:99], v[176:179]
    v_mfma_f32_16x16x32_bf16 v[172:175], v[232:235], v[248:251], v[172:175]
    ds_read_b32 v239, v238
    ds_read_b128 v[196:199], v237 offset:6144
    v_mfma_f32_16x16x32_bf16 v[176:179], v[232:235], v[252:255], v[176:179]
    s_waitcnt lgkmcnt(3)
    ds_read2st64_b32 v[188:189], v236 offset0:96 offset1:97
    ds_read2st64_b32 v[190:191], v236 offset0:98 offset1:99
    v_mfma_f32_16x16x32_bf16 v[172:175], v[216:219], v[200:203], v[172:175]
    s_waitcnt lgkmcnt(4)
    ds_read2st64_b32 v[192:193], v243 offset0:96 offset1:97
    ds_read2st64_b32 v[194:195], v243 offset0:98 offset1:99
    v_mfma_f32_16x16x32_bf16 v[176:179], v[220:223], v[200:203], v[176:179]
    v_mfma_f32_16x16x32_bf16 v[180:183], v[136:139], v[32:35], 0
    v_mfma_f32_16x16x32_bf16 v[184:187], v[136:139], v[100:103], 0
    ds_read_b128 v[136:139], v245 offset:4064
    v_mfma_f32_16x16x32_bf16 v[180:183], v[140:143], v[36:39], v[180:183]
    v_mfma_f32_16x16x32_bf16 v[184:187], v[140:143], v[104:107], v[184:187]
    s_waitcnt lgkmcnt(6)
    ds_read_b128 v[140:143], v245 offset:4000
    v_cmp_ge_u32 vcc, 6, v239
    v_mfma_f32_16x16x32_bf16 v[180:183], v[144:147], v[40:43], v[180:183]
    s_cbranch_vccnz L_retry6
L_back6:
    s_waitcnt lgkmcnt(5)
    v_add_f32 v172, v172, v188
    v_add_f32 v173, v173, v189
    v_mfma_f32_16x16x32_bf16 v[184:187], v[144:147], v[108:111], v[184:187]
    s_waitcnt lgkmcnt(4)
    ds_read_b128 v[144:147], v245 offset:3936
    v_add_f32 v174, v174, v190
    v_mfma_f32_16x16x32_bf16 v[180:183], v[148:151], v[44:47], v[180:183]
    s_waitcnt lgkmcnt(4)
    v_add_f32 v175, v175, v191
    v_add_f32 v176, v176, v192
    v_mfma_f32_16x16x32_bf16 v[184:187], v[148:151], v[112:115], v[184:187]
    ds_read_b128 v[148:151], v245 offset:3872
    v_add_f32 v177, v177, v193
    v_mfma_f32_16x16x32_bf16 v[180:183], v[152:155], v[48:51], v[180:183]
    s_waitcnt lgkmcnt(4)
    v_add_f32 v178, v178, v194
    v_add_f32 v179, v179, v195
    v_mfma_f32_16x16x32_bf16 v[184:187], v[152:155], v[116:119], v[184:187]
    ds_read_b128 v[152:155], v245 offset:3808
    v_sub_f32 v172, v172, v176
    v_mfma_f32_16x16x32_bf16 v[180:183], v[156:159], v[52:55], v[180:183]
    ds_read_b128 v[216:219], v247 offset:1804
    ds_read_b128 v[220:223], v247 offset:9740
    v_mfma_f32_16x16x32_bf16 v[184:187], v[156:159], v[120:123], v[184:187]
    ds_read_b128 v[156:159], v245 offset:3744
    ds_read_b128 v[224:227], v247 offset:1740
    v_mfma_f32_16x16x32_bf16 v[180:183], v[160:163], v[56:59], v[180:183]
    ds_read_b128 v[228:231], v247 offset:9676
    ds_read_b128 v[232:235], v245 offset:2016
    v_mfma_f32_16x16x32_bf16 v[184:187], v[160:163], v[124:127], v[184:187]
    ds_read_b128 v[160:163], v245 offset:3680
    v_sub_f32 v173, v173, v177
    v_mfma_f32_16x16x32_bf16 v[180:183], v[164:167], v[60:63], v[180:183]
    v_sub_f32 v174, v174, v178
    v_sub_f32 v175, v175, v179
    v_mfma_f32_16x16x32_bf16 v[184:187], v[164:167], v[128:131], v[184:187]
    ds_read_b128 v[164:167], v245 offset:3616
    v_fma_f32 v172, v196, v172, v176
    v_mfma_f32_16x16x32_bf16 v[180:183], v[168:171], v[64:67], v[180:183]
    v_fma_f32 v173, v197, v173, v177
    v_fma_f32 v174, v198, v174, v178
    v_mfma_f32_16x16x32_bf16 v[184:187], v[168:171], v[132:135], v[184:187]
    s_waitcnt lgkmcnt(12)
    v_fma_f32 v175, v199, v175, v179
    v_cvt_pk_bf16_f32 v240, v172, v173
    v_mfma_f32_16x16x32_bf16 v[180:183], v[136:139], v[0:3], v[180:183]
    v_cvt_pk_bf16_f32 v241, v174, v175
    v_mov_b32 v242, 7
    v_mfma_f32_16x16x32_bf16 v[184:187], v[136:139], v[68:71], v[184:187]
    s_waitcnt lgkmcnt(11)
    ds_write_addtid_b32 v240 offset:48896
    ds_write_addtid_b32 v241 offset:49152
    v_mfma_f32_16x16x32_bf16 v[180:183], v[140:143], v[4:7], v[180:183]
    ds_write_addtid_b32 v242 offset:49920
    v_mfma_f32_16x16x32_bf16 v[184:187], v[140:143], v[72:75], v[184:187]
    s_waitcnt lgkmcnt(13)
    v_mfma_f32_16x16x32_bf16 v[180:183], v[144:147], v[8:11], v[180:183]
    s_wakeup
    v_mfma_f32_16x16x32_bf16 v[184:187], v[144:147], v[76:79], v[184:187]
    s_waitcnt lgkmcnt(12)
    v_mfma_f32_16x16x32_bf16 v[180:183], v[148:151], v[12:15], v[180:183]
    v_mfma_f32_16x16x32_bf16 v[184:187], v[148:151], v[80:83], v[184:187]
    s_waitcnt lgkmcnt(10)
    v_mfma_f32_16x16x32_bf16 v[180:183], v[216:219], v[212:215], v[180:183]
    s_waitcnt lgkmcnt(9)
    v_mfma_f32_16x16x32_bf16 v[184:187], v[220:223], v[212:215], v[184:187]
    s_waitcnt lgkmcnt(7)
    ds_read_b128 v[216:219], v247 offset:1676
    ds_read_b128 v[220:223], v247 offset:9612
    v_mfma_f32_16x16x32_bf16 v[180:183], v[224:227], v[208:211], v[180:183]
    s_waitcnt lgkmcnt(8)
    ds_read_b32 v239, v238
    ds_read_b128 v[196:199], v237 offset:7168
    v_mfma_f32_16x16x32_bf16 v[184:187], v[228:231], v[208:211], v[184:187]
    ds_read_b128 v[224:227], v247 offset:1612
    ds_read_b128 v[228:231], v247 offset:9548
    v_mfma_f32_16x16x32_bf16 v[180:183], v[152:155], v[16:19], v[180:183]
    ds_read2st64_b32 v[188:189], v236 offset0:120 offset1:121
    ds_read2st64_b32 v[190:191], v236 offset0:122 offset1:123
    v_mfma_f32_16x16x32_bf16 v[180:183], v[156:159], v[20:23], v[180:183]
    s_wakeup
    s_waitcnt lgkmcnt(12)
    ds_read2st64_b32 v[192:193], v243 offset0:120 offset1:121
    ds_read2st64_b32 v[194:195], v243 offset0:122 offset1:123
    v_mfma_f32_16x16x32_bf16 v[180:183], v[160:163], v[24:27], v[180:183]
    s_waitcnt lgkmcnt(13)
    v_mfma_f32_16x16x32_bf16 v[180:183], v[164:167], v[28:31], v[180:183]
    v_mfma_f32_16x16x32_bf16 v[180:183], v[232:235], v[248:251], v[180:183]
    s_waitcnt lgkmcnt(9)
    v_mfma_f32_16x16x32_bf16 v[180:183], v[216:219], v[204:207], v[180:183]
    s_waitcnt lgkmcnt(5)
    v_mfma_f32_16x16x32_bf16 v[180:183], v[224:227], v[200:203], v[180:183]
    v_cmp_ge_u32 vcc, 7, v239
    v_mfma_f32_16x16x32_bf16 v[184:187], v[152:155], v[84:87], v[184:187]
    s_cbranch_vccnz L_retry7
L_back7:
    s_waitcnt lgkmcnt(1)
    v_sub_f32 v188, v188, v192
    v_sub_f32 v189, v189, v193
    v_mfma_f32_16x16x32_bf16 v[184:187], v[156:159], v[88:91], v[184:187]
    s_waitcnt lgkmcnt(0)
    v_sub_f32 v190, v190, v194
    v_sub_f32 v191, v191, v195
    v_mfma_f32_16x16x32_bf16 v[184:187], v[160:163], v[92:95], v[184:187]
    v_mov_b32 v242, 8
    v_add_f32 v188, v188, v180
    v_mfma_f32_16x16x32_bf16 v[184:187], v[164:167], v[96:99], v[184:187]
    v_add_f32 v189, v189, v181
    v_add_f32 v190, v190, v182
    v_mfma_f32_16x16x32_bf16 v[184:187], v[232:235], v[252:255], v[184:187]
    v_add_f32 v191, v191, v183
    v_fma_f32 v188, v196, v188, v192
    v_mfma_f32_16x16x32_bf16 v[184:187], v[220:223], v[204:207], v[184:187]
    v_fma_f32 v189, v197, v189, v193
    v_fma_f32 v190, v198, v190, v194
    v_mfma_f32_16x16x32_bf16 v[184:187], v[228:231], v[200:203], v[184:187]
    v_fma_f32 v191, v199, v191, v195
    v_sub_f32 v196, 1.0, v196
    v_sub_f32 v197, 1.0, v197
    v_sub_f32 v198, 1.0, v198
    v_sub_f32 v199, 1.0, v199
    s_nop 2
    v_fma_f32 v188, v196, v184, v188
    v_fma_f32 v189, v197, v185, v189
    v_fma_f32 v190, v198, v186, v190
    v_fma_f32 v191, v199, v187, v191
    v_cvt_pk_bf16_f32 v240, v188, v189
    v_cvt_pk_bf16_f32 v241, v190, v191
    ds_write_addtid_b32 v240 offset:49408
    ds_write_addtid_b32 v241 offset:49664
    ds_write_addtid_b32 v242 offset:49920
    s_waitcnt lgkmcnt(0)
    s_wakeup
    s_sleep 2
    s_wakeup
    s_branch L_fin
L_retry0:
    s_sub_u32 s75, s75, 1
    s_cbranch_scc1 L_end
    ds_read_b32 v239, v238
    ds_read_b128 v[196:199], v237 offset:0
    s_waitcnt lgkmcnt(0)
    v_cmp_ge_u32 vcc, 0, v239
    s_cbranch_vccnz L_retry0
    s_branch L_back0
L_retry1:
    s_sub_u32 s75, s75, 1
    s_cbranch_scc1 L_end
    ds_read_b32 v239, v238
    ds_read_b128 v[196:199], v237 offset:1024
    s_waitcnt lgkmcnt(0)
    v_cmp_ge_u32 vcc, 1, v239
    s_cbranch_vccnz L_retry1
    s_branch L_back1
L_retry2:
    s_sub_u32 s75, s75, 1
    s_cbranch_scc1 L_end
    ds_read_b32 v239, v238
    ds_read_b128 v[196:199], v237 offset:2048
    ds_read2st64_b32 v[188:189], v236 offset0:0 offset1:1
    ds_read2st64_b32 v[190:191], v236 offset0:2 offset1:3
    ds_read2st64_b32 v[192:193], v243 offset0:0 offset1:1
    ds_read2st64_b32 v[194:195], v243 offset0:2 offset1:3
    s_waitcnt lgkmcnt(0)
    v_cmp_ge_u32 vcc, 2, v239
    s_cbranch_vccnz L_retry2
    s_branch L_back2
L_retry3:
    s_sub_u32 s75, s75, 1
    s_cbranch_scc1 L_end
    ds_read_b32 v239, v238
    ds_read_b128 v[196:199], v237 offset:3072
    ds_read2st64_b32 v[188:189], v236 offset0:24 offset1:25
    ds_read2st64_b32 v[190:191], v236 offset0:26 offset1:27
    ds_read2st64_b32 v[192:193], v243 offset0:24 offset1:25
    ds_read2st64_b32 v[194:195], v243 offset0:26 offset1:27
    s_waitcnt lgkmcnt(0)
    v_cmp_ge_u32 vcc, 3, v239
    s_cbranch_vccnz L_retry3
    s_branch L_back3
L_retry4:
    s_sub_u32 s75, s75, 1
    s_cbranch_scc1 L_end
    ds_read_b32 v239, v238
    ds_read_b128 v[196:199], v237 offset:4096
    ds_read2st64_b32 v[188:189], v236 offset0:48 offset1:49
    ds_read2st64_b32 v[190:191], v236 offset0:50 offset1:51
    ds_read2st64_b32 v[192:193], v243 offset0:48 offset1:49
    ds_read2st64_b32 v[194:195], v243 offset0:50 offset1:51
    s_waitcnt lgkmcnt(0)
    v_cmp_ge_u32 vcc, 4, v239
    s_cbranch_vccnz L_retry4
    s_branch L_back4
L_retry5:
    s_sub_u32 s75, s75, 1
    s_cbranch_scc1 L_end
    ds_read_b32 v239, v238
    ds_read_b128 v[196:199], v237 offset:5120
    ds_read2st64_b32 v[188:189], v236 offset0:72 offset1:73
    ds_read2st64_b32 v[190:191], v236 offset0:74 offset1:75
    ds_read2st64_b32 v[192:193], v243 offset0:72 offset1:73
    ds_read2st64_b32 v[194:195], v243 offset0:74 offset1:75
    s_waitcnt lgkmcnt(0)
    v_cmp_ge_u32 vcc, 5, v239
    s_cbranch_vccnz L_retry5
    s_branch L_back5
L_retry6:
    s_sub_u32 s75, s75, 1
    s_cbranch_scc1 L_end
    ds_read_b32 v239, v238
    ds_read_b128 v[196:199], v237 offset:6144
    ds_read2st64_b32 v[188:189], v236 offset0:96 offset1:97
    ds_read2st64_b32 v[190:191], v236 offset0:98 offset1:99
    ds_read2st64_b32 v[192:193], v243 offset0:96 offset1:97
    ds_read2st64_b32 v[194:195], v243 offset0:98 offset1:99
    s_waitcnt lgkmcnt(0)
    v_cmp_ge_u32 vcc, 6, v239
    s_cbranch_vccnz L_retry6
    s_branch L_back6
L_retry7:
    s_sub_u32 s75, s75, 1
    s_cbranch_scc1 L_end
    ds_read_b32 v239, v238
    ds_read_b128 v[196:199], v237 offset:7168
    ds_read2st64_b32 v[188:189], v236 offset0:120 offset1:121
    ds_read2st64_b32 v[190:191], v236 offset0:122 offset1:123
    ds_read2st64_b32 v[192:193], v243 offset0:120 offset1:121
    ds_read2st64_b32 v[194:195], v243 offset0:122 offset1:123
    s_waitcnt lgkmcnt(0)
    v_cmp_ge_u32 vcc, 7, v239
    s_cbranch_vccnz L_retry7
    s_branch L_back7
L_fin:
L_end:
    s_endpgm
.p2align 7
.type L_tab,@object
L_tab:
.short 16128, 13824, 20736, 1136, 0, 1136, 1324, 128
.short 16416, 14112, 21024, 1152, 16, 1120, 1292, 2110
.short 16704, 14400, 21312, 1168, 32, 1104, 1260, 4092
.short 16992, 14688, 21600, 1184, 48, 1088, 1228, 6074
.short 17280, 16128, 18432, 1200, 64, 1072, 1516, 126
.short 17568, 16416, 18720, 1216, 80, 1056, 1484, 2108
.short 17856, 16704, 19008, 1232, 96, 1040, 1452, 4090
.short 18144, 16992, 19296, 1248, 112, 1024, 1420, 6072
.short 18432, 17280, 17856, 1328, 128, 1008, 1852, 124
.short 18720, 17280, 17856, 1344, 144, 992, 1820, 2106
.short 19008, 17568, 18144, 1360, 160, 976, 1788, 4088
.short 19296, 17856, 19584, 1376, 176, 960, 1756, 6070
.short 19584, 14976, 15552, 1392, 192, 944, 1724, 122
.short 19872, 14976, 15552, 1408, 208, 928, 1692, 2104
.short 20160, 15264, 15840, 1424, 224, 912, 1660, 4086
.short 20448, 15552, 19872, 1440, 240, 896, 1628, 6068
.short 16144, 13840, 20752, 1520, 1984, 880, 1316, 130
.short 16432, 14128, 21040, 1536, 2000, 864, 1284, 2112
.short 16720, 14416, 21328, 1552, 2016, 848, 1252, 4094
.short 17008, 14704, 21616, 1568, 2032, 832, 1220, 6076
.short 17296, 16144, 18448, 1584, 2048, 816, 1508, 132
.short 17584, 16432, 18736, 1600, 2064, 800, 1476, 2114
.short 17872, 16720, 19024, 1616, 2080, 784, 1444, 4096
.short 18160, 17008, 19312, 1632, 2096, 768, 1412, 6078
.short 18448, 17296, 17872, 1856, 2112, 752, 1844, 56
.short 18736, 17296, 17872, 1872, 2128, 736, 1812, 2038
.short 19024, 17584, 18160, 1888, 2144, 720, 1780, 4020
.short 19312, 17872, 19600, 1904, 2160, 704, 1748, 6002
.short 19600, 14992, 15568, 1920, 2176, 688, 1716, 54
.short 19888, 14992, 15568, 1936, 2192, 672, 1684, 2036
.short 20176, 15280, 15856, 1952, 2208, 656, 1652, 4018
.short 20464, 15568, 19888, 1968, 2224, 640, 1620, 6000
.short 16160, 13856, 20768, 3120, 3968, 624, 1308, 128
.short 16448, 14144, 21056, 3136, 3984, 608, 1276, 2110
.short 16736, 14432, 21344, 3152, 4000, 592, 1244, 4092
.short 17024, 14720, 21632, 3168, 4016, 576, 1212, 6074
.short 17312, 16160, 18464, 3184, 4032, 560, 1500, 126
.short 17600, 16448, 18752, 3200, 4048, 544, 1468, 2108
.short 17888, 16736, 19040, 3216, 4064, 528, 1436, 4090
.short 18176, 17024, 19328, 3232, 4080, 512, 1404, 6072
.short 18464, 17312, 17888, 3312, 4096, 496, 1836, 124
.short 18752, 17312, 17888, 3328, 4112, 480, 1804, 2106
.short 19040, 17600, 18176, 3344, 4128, 464, 1772, 4088
.short 19328, 17888, 19616, 3360, 4144, 448, 1740, 6070
.short 19616, 15008, 15584, 3376, 4160, 432, 1708, 122
.short 19904, 15008, 15584, 3392, 4176, 416, 1676, 2104
.short 20192, 15296, 15872, 3408, 4192, 400, 1644, 4086
.short 20480, 15584, 19904, 3424, 4208, 384, 1612, 6068
.short 16176, 13872, 20784, 3504, 5952, 368, 1300, 130
.short 16464, 14160, 21072, 3520, 5968, 352, 1268, 2112
.short 16752, 14448, 21360, 3536, 5984, 336, 1236, 4094
.short 17040, 14736, 21648, 3552, 6000, 320, 1204, 6076
.short 17328, 16176, 18480, 3568, 6016, 304, 1492, 132
.short 17616, 16464, 18768, 3584, 6032, 288, 1460, 2114
.short 17904, 16752, 19056, 3600, 6048, 272, 1428, 4096
.short 18192, 17040, 19344, 3616, 6064, 256, 1396, 6078
.short 18480, 17328, 17904, 3840, 6080, 240, 1828, 56
.short 18768, 17328, 17904, 3856, 6096, 224, 1796, 2038
.short 19056, 17616, 18192, 3872, 6112, 208, 1764, 4020
.short 19344, 17904, 19632, 3888, 6128, 192, 1732, 6002
.short 19632, 15024, 15600, 3904, 6144, 176, 1700, 54
.short 19920, 15024, 15600, 3920, 6160, 160, 1668, 2036
.short 20208, 15312, 15888, 3936, 6176, 144, 1636, 4018
.short 20496, 15600, 19920, 3952, 6192, 128, 1604, 6000
.short 5976, 6004, 0, 0, 0, 0, 0, 0
.short 3992, 4020, 32, 4, 2, 4384, 4384, 0
.short 2008, 2036, 64, 8, 4, 8768, 8768, 0
.short 24, 52, 96, 12, 6, 13152, 13152, 0
.short 5968, 5988, 128, 0, 1280, 4, 0, 0
.short 3984, 4004, 160, 4, 1282, 4388, 4384, 0
.short 2000, 2020, 192, 8, 1284, 8772, 8768, 0
.short 16, 36, 224, 12, 1286, 13156, 13152, 0
.short 5960, 5972, 256, 0, 2560, 8, 0, 0
.short 3976, 3988, 288, 4, 2562, 4392, 4384, 0
.short 1992, 2004, 320, 8, 2564, 8776, 8768, 0
.short 8, 20, 352, 12, 2566, 13160, 13152, 0
.short 5952, 5956, 384, 0, 3840, 12, 0, 0
.short 3968, 3972, 416, 4, 3842, 4396, 4384, 0
.short 1984, 1988, 448, 8, 3844, 8780, 8768, 0
.short 0, 4, 480, 12, 3846, 13164, 13152, 0
.short 5992, 6020, 16, 0, 5120, 16, 0, 0
.short 4008, 4036, 48, 4, 5122, 4400, 4384, 0
.short 2024, 2052, 80, 8, 5124, 8784, 8768, 0
.short 40, 68, 112, 12, 5126, 13168, 13152, 0
.short 5984, 6004, 144, 0, 6400, 20, 0, 0
.short 4000, 4020, 176, 4, 6402, 4404, 4384, 0
.short 2016, 2036, 208, 8, 6404, 8788, 8768, 0
.short 32, 52, 240, 12, 6406, 13172, 13152, 0
.short 5976, 5988, 272, 0, 7680, 24, 0, 0
.short 3992, 4004, 304, 4, 7682, 4408, 4384, 0
.short 2008, 2020, 336, 8, 7684, 8792, 8768, 0
.short 24, 36, 368, 12, 7686, 13176, 13152, 0
.short 5968, 5972, 400, 0, 8960, 28, 0, 0
.short 3984, 3988, 432, 4, 8962, 4412, 4384, 0
.short 2000, 2004, 464, 8, 8964, 8796, 8768, 0
.short 16, 20, 496, 12, 8966, 13180, 13152, 0
.short 6008, 6036, 32, 0, 10240, 32, 0, 0
.short 4024, 4052, 64, 4, 10242, 4416, 4384, 0
.short 2040, 2068, 96, 8, 10244, 8800, 8768, 0
.short 56, 84, 128, 12, 10246, 13184, 13152, 0
.short 6000, 6020, 160, 0, 11520, 36, 0, 0
.short 4016, 4036, 192, 4, 11522, 4420, 4384, 0
.short 2032, 2052, 224, 8, 11524, 8804, 8768, 0
.short 48, 68, 256, 12, 11526, 13188, 13152, 0
.short 5992, 6004, 288, 0, 12800, 40, 0, 0
.short 4008, 4020, 320, 4, 12802, 4424, 4384, 0
.short 2024, 2036, 352, 8, 12804, 8808, 8768, 0
.short 40, 52, 384, 12, 12806, 13192, 13152, 0
.short 5984, 5988, 416, 0, 14080, 44, 0, 0
.short 4000, 4004, 448, 4, 14082, 4428, 4384, 0
.short 2016, 2020, 480, 8, 14084, 8812, 8768, 0
.short 32, 36, 512, 12, 14086, 13196, 13152, 0
.short 6024, 6052, 48, 0, 15360, 48, 0, 0
.short 4040, 4068, 80, 4, 15362, 4432, 4384, 0
.short 2056, 2084, 112, 8, 15364, 8816, 8768, 0
.short 72, 100, 144, 12, 15366, 13200, 13152, 0
.short 6016, 6036, 176, 0, 16640, 52, 0, 0
.short 4032, 4052, 208, 4, 16642, 4436, 4384, 0
.short 2048, 2068, 240, 8, 16644, 8820, 8768, 0
.short 64, 84, 272, 12, 16646, 13204, 13152, 0
.short 6008, 6020, 304, 0, 17920, 56, 0, 0
.short 4024, 4036, 336, 4, 17922, 4440, 4384, 0
.short 2040, 2052, 368, 8, 17924, 8824, 8768, 0
.short 56, 68, 400, 12, 17926, 13208, 13152, 0
.short 6000, 6004, 432, 0, 19200, 60, 0, 0
.short 4016, 4020, 464, 4, 19202, 4444, 4384, 0
.short 2032, 2036, 496, 8, 19204, 8828, 8768, 0
.short 48, 52, 528, 12, 19206, 13212, 13152, 0
.short 0, 0, 0, 0, 0, 0, 0, 0
.short 0, 0, 0, 0, 0, 0, 0, 0
.short 0, 0, 0, 0, 0, 0, 0, 0
.short 0, 0, 0, 0, 0, 0, 0, 0
.short 0, 0, 0, 0, 0, 0, 0, 0
.short 0, 0, 0, 0, 0, 0, 0, 0
.short 0, 0, 0, 0, 0, 0, 0, 0
.short 0, 0, 0, 0, 0, 0, 0, 0
.short 0, 0, 0, 0, 0, 0, 0, 0
.short 0, 0, 0, 0, 0, 0, 0, 0
.short 0, 0, 0, 0, 0, 0, 0, 0
.short 0, 0, 0, 0, 0, 0, 0, 0
.short 0, 0, 0, 0, 0, 0, 0, 0
.short 0, 0, 0, 0, 0, 0, 0, 0
.short 0, 0, 0, 0, 0, 0, 0, 0
.short 0, 0, 0, 0, 0, 0, 0, 0
.short 0, 0, 0, 0x3f80, 0x3f80, 0x3f80, 0, 0
.short 0, 0, 0, 0, 0x3f80, 0x3f80, 0x3f80, 0
.short 0, 0, 0, 0, 0, 0x3f80, 0x3f80, 0x3f80
.short 0, 0, 0, 0, 0, 0, 0x3f80, 0x3f80
.short 0, 0, 0, 0, 0, 0, 0, 0x3f80
.short 0, 0, 0, 0, 0, 0, 0, 0
.short 0, 0, 0, 0, 0, 0, 0, 0
.short 0, 0, 0, 0, 0, 0, 0, 0
.short 0, 0, 0, 0, 0, 0, 0, 0
.short 0, 0, 0, 0, 0, 0, 0, 0
.short 0, 0, 0, 0, 0, 0, 0, 0
.short 0, 0, 0, 0, 0, 0, 0, 0
.short 0, 0, 0, 0, 0, 0, 0, 0
.short 0, 0, 0, 0, 0, 0, 0, 0
.short 0, 0, 0, 0, 0, 0, 0, 0
.short 0, 0, 0, 0, 0, 0, 0, 0
.short 0, 0, 0, 0, 0, 0, 0, 0
.short 0, 0, 0, 0, 0, 0, 0, 0
.short 0, 0, 0, 0, 0, 0, 0, 0
.short 0x3f80, 0, 0, 0, 0, 0, 0, 0
.short 0x3f80, 0x3f80, 0, 0, 0, 0, 0, 0
.short 0x3f80, 0x3f80, 0x3f80, 0, 0, 0, 0, 0
.short 0, 0x3f80, 0x3f80, 0x3f80, 0, 0, 0, 0
.short 0, 0, 0x3f80, 0x3f80, 0x3f80, 0, 0, 0
.short 0, 0, 0, 0x3f80, 0x3f80, 0x3f80, 0, 0
.short 0, 0, 0, 0, 0x3f80, 0x3f80, 0x3f80, 0
.short 0, 0, 0, 0, 0, 0x3f80, 0x3f80, 0x3f80
.short 0, 0, 0, 0, 0, 0, 0x3f80, 0x3f80
.short 0, 0, 0, 0, 0, 0, 0, 0x3f80
.short 0, 0, 0, 0, 0, 0, 0, 0
.short 0, 0, 0, 0, 0, 0, 0, 0
.short 0, 0, 0, 0, 0, 0, 0, 0
.short 0, 0, 0, 0, 0, 0, 0, 0
.short 0, 0, 0, 0, 0, 0, 0, 0
.short 0, 0, 0, 0, 0, 0, 0, 0
.short 0, 0, 0, 0, 0, 0, 0, 0
.short 0, 0, 0, 0, 0, 0, 0, 0
.short 0, 0, 0, 0, 0, 0, 0, 0
.short 0, 0, 0, 0, 0, 0, 0, 0
.short 0, 0, 0, 0, 0, 0, 0, 0
.short 0, 0, 0, 0, 0, 0, 0, 0
.short 0, 0, 0, 0, 0, 0, 0, 0
.short 0, 0, 0, 0, 0, 0, 0, 0
.short 0x3f80, 0, 0, 0, 0, 0, 0, 0
.short 0x3f80, 0x3f80, 0, 0, 0, 0, 0, 0
.short 0x3f80, 0x3f80, 0x3f80, 0, 0, 0, 0, 0
.short 0, 0x3f80, 0x3f80, 0x3f80, 0, 0, 0, 0
.short 0, 0, 0x3f80, 0x3f80, 0x3f80, 0, 0, 0
.short 0, 0, 0, 0, 0, 0, 0x3f80, 0x3f80
.short 0, 0, 0, 0, 0, 0, 0, 0x3f80
.short 0, 0, 0, 0, 0, 0, 0, 0
.short 0, 0, 0, 0, 0, 0, 0, 0
.short 0, 0, 0, 0, 0, 0, 0, 0
.short 0, 0, 0, 0, 0, 0, 0, 0
.short 0, 0, 0, 0, 0, 0, 0, 0
.short 0, 0, 0, 0, 0, 0, 0, 0
.short 0, 0, 0, 0, 0, 0, 0, 0
.short 0, 0, 0, 0, 0, 0, 0, 0
.short 0, 0, 0, 0, 0, 0, 0, 0
.short 0, 0, 0, 0, 0, 0, 0, 0
.short 0, 0, 0, 0, 0, 0, 0, 0
.short 0, 0, 0, 0, 0, 0, 0, 0
.short 0, 0, 0, 0, 0, 0, 0, 0
.short 0, 0, 0, 0, 0, 0, 0, 0
.short 0x3f80, 0x3f80, 0x3f80, 0, 0, 0, 0, 0
.short 0x3f80, 0x3f80, 0x3f80, 0x3f80, 0, 0, 0, 0
.short 0x3f80, 0x3f80, 0x3f80, 0x3f80, 0x3f80, 0, 0, 0
.short 0, 0x3f80, 0x3f80, 0x3f80, 0x3f80, 0x3f80, 0, 0
.short 0, 0, 0x3f80, 0x3f80, 0x3f80, 0x3f80, 0x3f80, 0
.short 0, 0, 0, 0x3f80, 0x3f80, 0x3f80, 0x3f80, 0x3f80
.short 0, 0, 0, 0, 0x3f80, 0x3f80, 0x3f80, 0x3f80
.short 0, 0, 0, 0, 0, 0x3f80, 0x3f80, 0x3f80
.short 0, 0, 0, 0, 0, 0, 0x3f80, 0x3f80
.short 0, 0, 0, 0, 0, 0, 0, 0x3f80
.short 0, 0, 0, 0, 0, 0, 0, 0
.short 0, 0, 0, 0, 0, 0, 0, 0
.short 0, 0, 0, 0, 0, 0, 0, 0
.short 0, 0, 0, 0, 0, 0, 0, 0
.short 0, 0, 0, 0, 0, 0, 0, 0
.short 0, 0, 0, 0, 0, 0, 0, 0
.short 0, 0, 0, 0, 0, 0, 0, 0
.short 0, 0, 0, 0, 0, 0, 0, 0
.short 0, 0, 0, 0, 0, 0, 0, 0
.short 0, 0, 0, 0, 0, 0, 0, 0
.short 0, 0, 0, 0, 0, 0, 0, 0
.short 0, 0, 0, 0, 0, 0, 0, 0
.short 0x3f80, 0, 0, 0, 0, 0, 0, 0
.short 0x3f80, 0x3f80, 0, 0, 0, 0, 0, 0
.short 0x3f80, 0x3f80, 0x3f80, 0, 0, 0, 0, 0
.short 0x3f80, 0x3f80, 0x3f80, 0x3f80, 0, 0, 0, 0
.short 0x3f80, 0x3f80, 0x3f80, 0x3f80, 0x3f80, 0, 0, 0
.short 0, 0x3f80, 0x3f80, 0x3f80, 0x3f80, 0x3f80, 0, 0
.short 0, 0, 0x3f80, 0x3f80, 0x3f80, 0x3f80, 0x3f80, 0
.short 0, 0, 0, 0x3f80, 0x3f80, 0x3f80, 0x3f80, 0x3f80
.short 0, 0, 0, 0, 0x3f80, 0x3f80, 0x3f80, 0x3f80
.short 0, 0, 0, 0, 0, 0x3f80, 0x3f80, 0x3f80
.short 0, 0, 0, 0, 0, 0, 0, 0
.short 0, 0, 0, 0, 0, 0, 0, 0
.short 0, 0, 0, 0, 0, 0, 0, 0
.short 0, 0, 0, 0, 0, 0, 0, 0
.short 0, 0, 0, 0, 0, 0, 0, 0
.short 0, 0, 0, 0, 0, 0, 0, 0
.short 0, 0, 0, 0, 0, 0, 0, 0
.short 0, 0, 0, 0, 0, 0, 0, 0
.short 0, 0, 0, 0, 0, 0, 0, 0
.short 0, 0, 0, 0, 0, 0, 0, 0
.short 0, 0, 0, 0, 0, 0, 0, 0
.short 0, 0, 0, 0, 0, 0, 0, 0
.short 0, 0, 0, 0, 0, 0, 0, 0
.short 0, 0, 0, 0, 0, 0, 0, 0
.short 0x3f80, 0, 0, 0, 0, 0, 0, 0
.short 0x3f80, 0x3f80, 0, 0, 0, 0, 0, 0
.short 0, 0, 0, 0, 0, 0x3f80, 0x3f80, 0x3f80
.short 0, 0, 0, 0, 0, 0, 0x3f80, 0x3f80
.short 0, 0, 0, 0, 0, 0, 0, 0x3f80
.short 0, 0, 0, 0, 0, 0, 0, 0
.short 0, 0, 0, 0, 0, 0, 0, 0
.short 0, 0, 0, 0, 0, 0, 0, 0
.short 0, 0, 0, 0, 0, 0, 0, 0
.short 0, 0, 0, 0, 0, 0, 0, 0
.short 0, 0, 0, 0, 0, 0, 0, 0
.short 0, 0, 0, 0, 0, 0, 0, 0
.short 0, 0, 0, 0, 0, 0, 0, 0
.short 0, 0, 0, 0, 0, 0, 0, 0
.short 0, 0, 0, 0, 0, 0, 0, 0
.short 0, 0, 0, 0, 0, 0, 0, 0
.short 0, 0, 0, 0, 0, 0, 0, 0
.short 0, 0, 0, 0, 0, 0, 0, 0
.short 0x3f80, 0x3f80, 0x3f80, 0x3f80, 0, 0, 0, 0
.short 0x3f80, 0x3f80, 0x3f80, 0x3f80, 0x3f80, 0, 0, 0
.short 0x3f80, 0x3f80, 0x3f80, 0x3f80, 0x3f80, 0x3f80, 0, 0
.short 0x3f80, 0x3f80, 0x3f80, 0x3f80, 0x3f80, 0x3f80, 0x3f80, 0
.short 0, 0x3f80, 0x3f80, 0x3f80, 0x3f80, 0x3f80, 0x3f80, 0x3f80
.short 0, 0, 0x3f80, 0x3f80, 0x3f80, 0x3f80, 0x3f80, 0x3f80
.short 0, 0, 0, 0x3f80, 0x3f80, 0x3f80, 0x3f80, 0x3f80
.short 0, 0, 0, 0, 0x3f80, 0x3f80, 0x3f80, 0x3f80
.short 0, 0, 0, 0, 0, 0x3f80, 0x3f80, 0x3f80
.short 0, 0, 0, 0, 0, 0, 0x3f80, 0x3f80
.short 0, 0, 0, 0, 0, 0, 0, 0x3f80
.short 0, 0, 0, 0, 0, 0, 0, 0
.short 0, 0, 0, 0, 0, 0, 0, 0
.short 0, 0, 0, 0, 0, 0, 0, 0
.short 0, 0, 0, 0, 0, 0, 0, 0
.short 0, 0, 0, 0, 0, 0, 0, 0
.short 0, 0, 0, 0, 0, 0, 0, 0
.short 0, 0, 0, 0, 0, 0, 0, 0
.short 0, 0, 0, 0, 0, 0, 0, 0
.short 0, 0, 0, 0, 0, 0, 0, 0
.short 0, 0, 0, 0, 0, 0, 0, 0
.short 0x3f80, 0, 0, 0, 0, 0, 0, 0
.short 0x3f80, 0x3f80, 0, 0, 0, 0, 0, 0
.short 0x3f80, 0x3f80, 0x3f80, 0, 0, 0, 0, 0
.short 0x3f80, 0x3f80, 0x3f80, 0x3f80, 0, 0, 0, 0
.short 0x3f80, 0x3f80, 0x3f80, 0x3f80, 0x3f80, 0, 0, 0
.short 0x3f80, 0x3f80, 0x3f80, 0x3f80, 0x3f80, 0x3f80, 0, 0
.short 0x3f80, 0x3f80, 0x3f80, 0x3f80, 0x3f80, 0x3f80, 0x3f80, 0
.short 0, 0x3f80, 0x3f80, 0x3f80, 0x3f80, 0x3f80, 0x3f80, 0x3f80
.short 0, 0, 0x3f80, 0x3f80, 0x3f80, 0x3f80, 0x3f80, 0x3f80
.short 0, 0, 0, 0x3f80, 0x3f80, 0x3f80, 0x3f80, 0x3f80
.short 0, 0, 0, 0, 0x3f80, 0x3f80, 0x3f80, 0x3f80
.short 0, 0, 0, 0, 0, 0, 0, 0
.short 0, 0, 0, 0, 0, 0, 0, 0
.short 0, 0, 0, 0, 0, 0, 0, 0
.short 0, 0, 0, 0, 0, 0, 0, 0
.short 0, 0, 0, 0, 0, 0, 0, 0
.short 0, 0, 0, 0, 0, 0, 0, 0
.short 0, 0, 0, 0, 0, 0, 0, 0
.short 0, 0, 0, 0, 0, 0, 0, 0
.short 0, 0, 0, 0, 0, 0, 0, 0
.short 0, 0, 0, 0, 0, 0, 0, 0
.short 0, 0, 0, 0, 0, 0, 0, 0
.short 0, 0, 0, 0, 0, 0, 0, 0
.short 0, 0, 0, 0, 0, 0, 0, 0
.short 0x3f80, 0, 0, 0, 0, 0, 0, 0
.short 0x3f80, 0x3f80, 0, 0, 0, 0, 0, 0
.short 0x3f80, 0x3f80, 0x3f80, 0, 0, 0, 0, 0
.short 0, 0, 0, 0, 0x3f80, 0x3f80, 0x3f80, 0x3f80
.short 0, 0, 0, 0, 0, 0x3f80, 0x3f80, 0x3f80
.short 0, 0, 0, 0, 0, 0, 0x3f80, 0x3f80
.short 0, 0, 0, 0, 0, 0, 0, 0x3f80
.short 0, 0, 0, 0, 0, 0, 0, 0
.short 0, 0, 0, 0, 0, 0, 0, 0
.short 0, 0, 0, 0, 0, 0, 0, 0
.short 0, 0, 0, 0, 0, 0, 0, 0
.short 0, 0, 0, 0, 0, 0, 0, 0
.short 0, 0, 0, 0, 0, 0, 0, 0
.short 0, 0, 0, 0, 0, 0, 0, 0
.short 0, 0, 0, 0, 0, 0, 0, 0
.short 0, 0, 0, 0, 0, 0, 0, 0
.short 0, 0, 0, 0, 0, 0, 0, 0
.short 0, 0, 0, 0, 0, 0, 0, 0
.short 0, 0, 0, 0, 0, 0, 0, 0
.short 0x3f80, 0x3f80, 0x3f80, 0x3f80, 0x3f80, 0, 0, 0
.short 0x3f80, 0x3f80, 0x3f80, 0x3f80, 0x3f80, 0x3f80, 0, 0
.short 0x3f80, 0x3f80, 0x3f80, 0x3f80, 0x3f80, 0x3f80, 0x3f80, 0
.short 0x3f80, 0x3f80, 0x3f80, 0x3f80, 0x3f80, 0x3f80, 0x3f80, 0x3f80
.short 0x3f80, 0x3f80, 0x3f80, 0x3f80, 0x3f80, 0x3f80, 0x3f80, 0x3f80
.short 0, 0x3f80, 0x3f80, 0x3f80, 0x3f80, 0x3f80, 0x3f80, 0x3f80
.short 0, 0, 0x3f80, 0x3f80, 0x3f80, 0x3f80, 0x3f80, 0x3f80
.short 0, 0, 0, 0x3f80, 0x3f80, 0x3f80, 0x3f80, 0x3f80
.short 0, 0, 0, 0, 0x3f80, 0x3f80, 0x3f80, 0x3f80
.short 0, 0, 0, 0, 0, 0x3f80, 0x3f80, 0x3f80
.short 0, 0, 0, 0, 0, 0, 0x3f80, 0x3f80
.short 0, 0, 0, 0, 0, 0, 0, 0x3f80
.short 0, 0, 0, 0, 0, 0, 0, 0
.short 0, 0, 0, 0, 0, 0, 0, 0
.short 0, 0, 0, 0, 0, 0, 0, 0
.short 0, 0, 0, 0, 0, 0, 0, 0
.short 0, 0, 0, 0, 0, 0, 0, 0
.short 0, 0, 0, 0, 0, 0, 0, 0
.short 0, 0, 0, 0, 0, 0, 0, 0
.short 0, 0, 0, 0, 0, 0, 0, 0
.short 0x3f80, 0, 0, 0, 0, 0, 0, 0
.short 0x3f80, 0x3f80, 0, 0, 0, 0, 0, 0
.short 0x3f80, 0x3f80, 0x3f80, 0, 0, 0, 0, 0
.short 0x3f80, 0x3f80, 0x3f80, 0x3f80, 0, 0, 0, 0
.short 0x3f80, 0x3f80, 0x3f80, 0x3f80, 0x3f80, 0, 0, 0
.short 0x3f80, 0x3f80, 0x3f80, 0x3f80, 0x3f80, 0x3f80, 0, 0
.short 0x3f80, 0x3f80, 0x3f80, 0x3f80, 0x3f80, 0x3f80, 0x3f80, 0
.short 0x3f80, 0x3f80, 0x3f80, 0x3f80, 0x3f80, 0x3f80, 0x3f80, 0x3f80
.short 0x3f80, 0x3f80, 0x3f80, 0x3f80, 0x3f80, 0x3f80, 0x3f80, 0x3f80
.short 0, 0x3f80, 0x3f80, 0x3f80, 0x3f80, 0x3f80, 0x3f80, 0x3f80
.short 0, 0, 0x3f80, 0x3f80, 0x3f80, 0x3f80, 0x3f80, 0x3f80
.short 0, 0, 0, 0x3f80, 0x3f80, 0x3f80, 0x3f80, 0x3f80
.short 0, 0, 0, 0, 0, 0, 0, 0
.short 0, 0, 0, 0, 0, 0, 0, 0
.short 0, 0, 0, 0, 0, 0, 0, 0
.short 0, 0, 0, 0, 0, 0, 0, 0
.short 0, 0, 0, 0, 0, 0, 0, 0
.short 0, 0, 0, 0, 0, 0, 0, 0
.short 0, 0, 0, 0, 0, 0, 0, 0
.short 0, 0, 0, 0, 0, 0, 0, 0
.short 0, 0, 0, 0, 0, 0, 0, 0
.short 0, 0, 0, 0, 0, 0, 0, 0
.short 0, 0, 0, 0, 0, 0, 0, 0
.short 0, 0, 0, 0, 0, 0, 0, 0
.short 0x3f80, 0, 0, 0, 0, 0, 0, 0
.short 0x3f80, 0x3f80, 0, 0, 0, 0, 0, 0
.short 0x3f80, 0x3f80, 0x3f80, 0, 0, 0, 0, 0
.short 0x3f80, 0x3f80, 0x3f80, 0x3f80, 0, 0, 0, 0
L_tabend:
.org L_pc + 512*45
.size L_tab, .-L_tab
L_codeend:
.section .rodata,"a"
.p2align 6
.amdhsa_kernel gated_mix__ssm_conv_s4__ssm_conv_s4d__prompt_kernel
  .amdhsa_next_free_vgpr 256
  .amdhsa_next_free_sgpr 102
  .amdhsa_accum_offset 256
  .amdhsa_group_segment_fixed_size 0
  .amdhsa_kernarg_size 160
  .amdhsa_user_sgpr_count 2
  .amdhsa_user_sgpr_kernarg_segment_ptr 1
  .amdhsa_system_sgpr_workgroup_id_x 1
.end_amdhsa_kernel
```
